```python
import torch

def _softmax(x, axis=-1):
    return torch.softmax(x, dim=axis)
def _gelu(x):
    return torch.nn.functional.gelu(x, approximate="tanh")
def _silu(x):
    return torch.nn.functional.silu(x)
def _sigmoid(x):
    return torch.sigmoid(x)
def _layernorm(x, axis=-1, eps=1e-5):
    m = x.mean(dim=axis, keepdim=True)
    v = x.var(dim=axis, keepdim=True, unbiased=False)
    return (x - m) / torch.sqrt(v + eps)
def _scatter_add(tgt, idx, src, axis=0):
    return tgt.clone().index_add_(axis, idx, src)
def _segment_sum(src, seg, n):
    out = torch.zeros((n,) + src.shape[1:], dtype=src.dtype)
    return out.index_add_(0, seg, src)
def _pad(x, pw):
    flat = tuple(v for pair in reversed(pw) for v in pair)
    return torch.nn.functional.pad(x, flat)

kernel_name = 'standalone__sliding_block_cached__sampling'

def setup_inputs():

    _w = (lambda a: (lambda t: t.to(torch.bfloat16) if t.is_floating_point() else t)(torch.as_tensor(a)))
    B, Sq, D = 32, 32, 512
    Hq, Hkv, Sk, Dh = 32, 8, 2048, 128
    assert Hq % Hkv == 0, (Hq, Hkv)
    return {
        "x": _w((lambda *s: torch.randn(*s, dtype=torch.bfloat16) * 0.8)(B, Sq, D)),
        "k_cache": _w((lambda *s: torch.randn(*s, dtype=torch.bfloat16) * 0.8)(B, Hkv, Sk, Dh)),
        "v_cache": _w((lambda *s: torch.randn(*s, dtype=torch.bfloat16) * 0.05)(B, Hkv, Sk, Dh)),
        "wq": _w((lambda *s: torch.randn(*s, dtype=torch.bfloat16) * 0.8)(D, Hq * Dh) * (D ** -0.5)),
        "wo": _w((lambda *s: torch.randn(*s, dtype=torch.bfloat16) * 0.05)(Hq * Dh, D) * ((Hq * Dh) ** -0.5)),
    }

def reference(x, k_cache, v_cache, wq, wo):
    B, Sq, D = x.shape
    Hq, Dh = 32, 128
    Hkv, Sk = k_cache.shape[1], k_cache.shape[2]
    W = min(4096, max(256, Sk // 4))
    rep = Hq // Hkv
    q = (lambda x, *d: x.permute(*d))((x @ wq).reshape(B, Sq, Hq, Dh), 0, 2, 1, 3)
    k = (lambda x, n, axis: torch.repeat_interleave(x, n, dim=axis))(k_cache[:, :, Sk - W:, :], rep, axis=1)
    v = (lambda x, n, axis: torch.repeat_interleave(x, n, dim=axis))(v_cache[:, :, Sk - W:, :], rep, axis=1)
    scores = torch.einsum("bhqd,bhkd->bhqk", q, k) * (Dh ** -0.5)
    p = _softmax(scores, axis=-1)
    o = torch.einsum("bhqk,bhkd->bhqd", p, v)
    return (lambda x, *d: x.permute(*d))(o, 0, 2, 1, 3).reshape(B, Sq, Hq * Dh) @ wo
```

```asm
; @launch grid=(256,1,1) block=(512,1,1) lds=163840
.amdgcn_target "amdgcn-amd-amdhsa--gfx950"
.text
.globl standalone__sliding_block_cached__sampling_kernel
.p2align 8
.type standalone__sliding_block_cached__sampling_kernel,@function
standalone__sliding_block_cached__sampling_kernel:
L_start:
    s_cmp_ge_u32 s2, 256
    s_cbranch_scc1 L_end
    s_load_dwordx4 s[4:7], s[0:1], 0
    s_load_dwordx4 s[8:11], s[0:1], 16
    s_load_dwordx4 s[12:15], s[0:1], 32
    s_load_dwordx4 s[16:19], s[0:1], 48
    v_lshrrev_b32 v1, 6, v0
    v_and_b32 v0, 63, v0
    v_readfirstlane_b32 s20, v1
    s_and_b32 s21, s2, 7
    s_lshr_b32 s22, s2, 3
    s_and_b32 s65, s22, 1
    s_mov_b32 s56, 0x05040100
    s_mov_b32 s57, 0x07060302
    s_lshr_b32 s58, s22, 1
    s_mov_b32 s59, 0
    s_mov_b32 s61, 0
    s_mov_b32 s63, 0x100000
    s_waitcnt lgkmcnt(0)
    s_cmp_ge_u32 s20, 4
    s_cbranch_scc1 L_B
    s_lshl_b32 s70, s22, 15
    s_add_u32 s44, s4, s70
    s_addc_u32 s45, s5, 0
    s_mov_b32 s46, 32768
    s_mov_b32 s47, 0x20000
    s_lshl_b32 s70, s21, 2
    s_add_u32 s70, s70, s20
    s_lshl_b32 s70, s70, 8
    s_add_u32 s24, s10, s70
    s_addc_u32 s25, s11, 0
    s_sub_u32 s26, 4194304, s70
    s_mov_b32 s27, 0x20000
    v_lshlrev_b32 v15, 4, v0
    v_and_b32 v11, 15, v0
    v_lshrrev_b32 v12, 4, v0
    v_lshlrev_b32 v1, 16, v12
    v_lshl_add_u32 v1, v11, 4, v1
    v_add_u32 v2, 8192, v1
    v_add_u32 v3, 16384, v1
    v_add_u32 v4, 24576, v1
    v_add_u32 v5, 32768, v1
    v_add_u32 v6, 40960, v1
    v_add_u32 v7, 49152, v1
    v_add_u32 v8, 57344, v1
    s_cmp_eq_u32 s65, 1
    s_cbranch_scc1 L_a_g1
    s_add_u32 s60, s58, s59
    s_and_b32 s60, s60, 15
    s_lshl_b32 s60, s60, 18
    s_add_u32 s59, s59, 1
    s_add_u32 s70, s20, 0
    s_and_b32 s71, s70, 15
    s_lshl_b32 s71, s71, 4
    s_lshl_b32 s70, s70, 10
    s_add_u32 m0, s70, 131072
    v_xor_b32 v13, s71, v15
    buffer_load_dwordx4 v13, s[44:47], s70 offen lds
    buffer_load_dwordx4 v[80:83], v1, s[24:27], s60 offen
    s_add_u32 s70, s20, 4
    s_and_b32 s71, s70, 15
    s_lshl_b32 s71, s71, 4
    s_lshl_b32 s70, s70, 10
    s_add_u32 m0, s70, 131072
    v_xor_b32 v13, s71, v15
    buffer_load_dwordx4 v13, s[44:47], s70 offen lds
    buffer_load_dwordx4 v[84:87], v2, s[24:27], s60 offen
    s_add_u32 s70, s20, 8
    s_and_b32 s71, s70, 15
    s_lshl_b32 s71, s71, 4
    s_lshl_b32 s70, s70, 10
    s_add_u32 m0, s70, 131072
    v_xor_b32 v13, s71, v15
    buffer_load_dwordx4 v13, s[44:47], s70 offen lds
    buffer_load_dwordx4 v[88:91], v3, s[24:27], s60 offen
    s_add_u32 s70, s20, 12
    s_and_b32 s71, s70, 15
    s_lshl_b32 s71, s71, 4
    s_lshl_b32 s70, s70, 10
    s_add_u32 m0, s70, 131072
    v_xor_b32 v13, s71, v15
    buffer_load_dwordx4 v13, s[44:47], s70 offen lds
    buffer_load_dwordx4 v[92:95], v4, s[24:27], s60 offen
    s_add_u32 s70, s20, 16
    s_and_b32 s71, s70, 15
    s_lshl_b32 s71, s71, 4
    s_lshl_b32 s70, s70, 10
    s_add_u32 m0, s70, 131072
    v_xor_b32 v13, s71, v15
    buffer_load_dwordx4 v13, s[44:47], s70 offen lds
    buffer_load_dwordx4 v[96:99], v5, s[24:27], s60 offen
    s_add_u32 s70, s20, 20
    s_and_b32 s71, s70, 15
    s_lshl_b32 s71, s71, 4
    s_lshl_b32 s70, s70, 10
    s_add_u32 m0, s70, 131072
    v_xor_b32 v13, s71, v15
    buffer_load_dwordx4 v13, s[44:47], s70 offen lds
    buffer_load_dwordx4 v[100:103], v6, s[24:27], s60 offen
    s_add_u32 s70, s20, 24
    s_and_b32 s71, s70, 15
    s_lshl_b32 s71, s71, 4
    s_lshl_b32 s70, s70, 10
    s_add_u32 m0, s70, 131072
    v_xor_b32 v13, s71, v15
    buffer_load_dwordx4 v13, s[44:47], s70 offen lds
    buffer_load_dwordx4 v[104:107], v7, s[24:27], s60 offen
    s_add_u32 s70, s20, 28
    s_and_b32 s71, s70, 15
    s_lshl_b32 s71, s71, 4
    s_lshl_b32 s70, s70, 10
    s_add_u32 m0, s70, 131072
    v_xor_b32 v13, s71, v15
    buffer_load_dwordx4 v13, s[44:47], s70 offen lds
    buffer_load_dwordx4 v[108:111], v8, s[24:27], s60 offen
    s_add_u32 s60, s58, s59
    s_and_b32 s60, s60, 15
    s_lshl_b32 s60, s60, 18
    s_add_u32 s59, s59, 1
    buffer_load_dwordx4 v[112:115], v1, s[24:27], s60 offen
    buffer_load_dwordx4 v[116:119], v2, s[24:27], s60 offen
    buffer_load_dwordx4 v[120:123], v3, s[24:27], s60 offen
    buffer_load_dwordx4 v[124:127], v4, s[24:27], s60 offen
    buffer_load_dwordx4 v[128:131], v5, s[24:27], s60 offen
    buffer_load_dwordx4 v[132:135], v6, s[24:27], s60 offen
    buffer_load_dwordx4 v[136:139], v7, s[24:27], s60 offen
    buffer_load_dwordx4 v[140:143], v8, s[24:27], s60 offen
    s_add_u32 s60, s58, s59
    s_and_b32 s60, s60, 15
    s_lshl_b32 s60, s60, 18
    s_add_u32 s59, s59, 1
    buffer_load_dwordx4 v[144:147], v1, s[24:27], s60 offen
    buffer_load_dwordx4 v[148:151], v2, s[24:27], s60 offen
    buffer_load_dwordx4 v[152:155], v3, s[24:27], s60 offen
    buffer_load_dwordx4 v[156:159], v4, s[24:27], s60 offen
    buffer_load_dwordx4 v[160:163], v5, s[24:27], s60 offen
    buffer_load_dwordx4 v[164:167], v6, s[24:27], s60 offen
    buffer_load_dwordx4 v[168:171], v7, s[24:27], s60 offen
    buffer_load_dwordx4 v[172:175], v8, s[24:27], s60 offen
    s_branch L_a_join
L_a_g1:
    s_add_u32 s70, s20, 0
    s_and_b32 s71, s70, 15
    s_lshl_b32 s71, s71, 4
    s_lshl_b32 s70, s70, 10
    s_add_u32 m0, s70, 131072
    v_xor_b32 v13, s71, v15
    buffer_load_dwordx4 v13, s[44:47], s70 offen lds
    s_add_u32 s70, s20, 4
    s_and_b32 s71, s70, 15
    s_lshl_b32 s71, s71, 4
    s_lshl_b32 s70, s70, 10
    s_add_u32 m0, s70, 131072
    v_xor_b32 v13, s71, v15
    buffer_load_dwordx4 v13, s[44:47], s70 offen lds
    s_add_u32 s70, s20, 8
    s_and_b32 s71, s70, 15
    s_lshl_b32 s71, s71, 4
    s_lshl_b32 s70, s70, 10
    s_add_u32 m0, s70, 131072
    v_xor_b32 v13, s71, v15
    buffer_load_dwordx4 v13, s[44:47], s70 offen lds
    s_add_u32 s70, s20, 12
    s_and_b32 s71, s70, 15
    s_lshl_b32 s71, s71, 4
    s_lshl_b32 s70, s70, 10
    s_add_u32 m0, s70, 131072
    v_xor_b32 v13, s71, v15
    buffer_load_dwordx4 v13, s[44:47], s70 offen lds
    s_add_u32 s70, s20, 16
    s_and_b32 s71, s70, 15
    s_lshl_b32 s71, s71, 4
    s_lshl_b32 s70, s70, 10
    s_add_u32 m0, s70, 131072
    v_xor_b32 v13, s71, v15
    buffer_load_dwordx4 v13, s[44:47], s70 offen lds
    s_add_u32 s70, s20, 20
    s_and_b32 s71, s70, 15
    s_lshl_b32 s71, s71, 4
    s_lshl_b32 s70, s70, 10
    s_add_u32 m0, s70, 131072
    v_xor_b32 v13, s71, v15
    buffer_load_dwordx4 v13, s[44:47], s70 offen lds
    s_add_u32 s70, s20, 24
    s_and_b32 s71, s70, 15
    s_lshl_b32 s71, s71, 4
    s_lshl_b32 s70, s70, 10
    s_add_u32 m0, s70, 131072
    v_xor_b32 v13, s71, v15
    buffer_load_dwordx4 v13, s[44:47], s70 offen lds
    s_add_u32 s70, s20, 28
    s_and_b32 s71, s70, 15
    s_lshl_b32 s71, s71, 4
    s_lshl_b32 s70, s70, 10
    s_add_u32 m0, s70, 131072
    v_xor_b32 v13, s71, v15
    buffer_load_dwordx4 v13, s[44:47], s70 offen lds
    s_barrier
    s_add_u32 s60, s58, s59
    s_and_b32 s60, s60, 15
    s_lshl_b32 s60, s60, 18
    s_add_u32 s59, s59, 1
    buffer_load_dwordx4 v[80:83], v1, s[24:27], s60 offen
    buffer_load_dwordx4 v[84:87], v2, s[24:27], s60 offen
    buffer_load_dwordx4 v[88:91], v3, s[24:27], s60 offen
    buffer_load_dwordx4 v[92:95], v4, s[24:27], s60 offen
    buffer_load_dwordx4 v[96:99], v5, s[24:27], s60 offen
    buffer_load_dwordx4 v[100:103], v6, s[24:27], s60 offen
    buffer_load_dwordx4 v[104:107], v7, s[24:27], s60 offen
    buffer_load_dwordx4 v[108:111], v8, s[24:27], s60 offen
    s_add_u32 s60, s58, s59
    s_and_b32 s60, s60, 15
    s_lshl_b32 s60, s60, 18
    s_add_u32 s59, s59, 1
    buffer_load_dwordx4 v[112:115], v1, s[24:27], s60 offen
    buffer_load_dwordx4 v[116:119], v2, s[24:27], s60 offen
    buffer_load_dwordx4 v[120:123], v3, s[24:27], s60 offen
    buffer_load_dwordx4 v[124:127], v4, s[24:27], s60 offen
    buffer_load_dwordx4 v[128:131], v5, s[24:27], s60 offen
    buffer_load_dwordx4 v[132:135], v6, s[24:27], s60 offen
    buffer_load_dwordx4 v[136:139], v7, s[24:27], s60 offen
    buffer_load_dwordx4 v[140:143], v8, s[24:27], s60 offen
    s_add_u32 s60, s58, s59
    s_and_b32 s60, s60, 15
    s_lshl_b32 s60, s60, 18
    s_add_u32 s59, s59, 1
    buffer_load_dwordx4 v[144:147], v1, s[24:27], s60 offen
    buffer_load_dwordx4 v[148:151], v2, s[24:27], s60 offen
    buffer_load_dwordx4 v[152:155], v3, s[24:27], s60 offen
    buffer_load_dwordx4 v[156:159], v4, s[24:27], s60 offen
    buffer_load_dwordx4 v[160:163], v5, s[24:27], s60 offen
    buffer_load_dwordx4 v[164:167], v6, s[24:27], s60 offen
    buffer_load_dwordx4 v[168:171], v7, s[24:27], s60 offen
    buffer_load_dwordx4 v[172:175], v8, s[24:27], s60 offen
L_a_join:
    v_xor_b32 v9, v11, v12
    v_lshlrev_b32 v9, 4, v9
    v_lshl_add_u32 v9, v11, 10, v9
    v_add_u32 v9, 131072, v9
    v_and_b32 v13, 3, v0
    v_lshlrev_b32 v13, 2, v13
    v_add_u32 v13, 114688, v13
    s_lshl_b32 s70, s20, 2
    s_add_u32 s70, s70, 114704
    v_mov_b32 v14, s70
    s_cmp_eq_u32 s20, 0
    s_cbranch_scc0 L_a_noz
    v_mov_b32 v15, 0
    ds_write_b32 v13, v15
    ds_write_b32 v13, v15 offset:16
    ds_write_b32 v13, v15 offset:32
L_a_noz:
    v_mov_b32 v16, 0
    v_mov_b32 v17, 0
    v_mov_b32 v18, 0
    v_mov_b32 v19, 0
    v_mov_b32 v20, 0
    v_mov_b32 v21, 0
    v_mov_b32 v22, 0
    v_mov_b32 v23, 0
    v_mov_b32 v24, 0
    v_mov_b32 v25, 0
    v_mov_b32 v26, 0
    v_mov_b32 v27, 0
    v_mov_b32 v28, 0
    v_mov_b32 v29, 0
    v_mov_b32 v30, 0
    v_mov_b32 v31, 0
    v_mov_b32 v32, 0
    v_mov_b32 v33, 0
    v_mov_b32 v34, 0
    v_mov_b32 v35, 0
    v_mov_b32 v36, 0
    v_mov_b32 v37, 0
    v_mov_b32 v38, 0
    v_mov_b32 v39, 0
    v_mov_b32 v40, 0
    v_mov_b32 v41, 0
    v_mov_b32 v42, 0
    v_mov_b32 v43, 0
    v_mov_b32 v44, 0
    v_mov_b32 v45, 0
    v_mov_b32 v46, 0
    v_mov_b32 v47, 0
    v_mov_b32 v48, 0
    v_mov_b32 v49, 0
    v_mov_b32 v50, 0
    v_mov_b32 v51, 0
    v_mov_b32 v52, 0
    v_mov_b32 v53, 0
    v_mov_b32 v54, 0
    v_mov_b32 v55, 0
    v_mov_b32 v56, 0
    v_mov_b32 v57, 0
    v_mov_b32 v58, 0
    v_mov_b32 v59, 0
    v_mov_b32 v60, 0
    v_mov_b32 v61, 0
    v_mov_b32 v62, 0
    v_mov_b32 v63, 0
    v_mov_b32 v64, 0
    v_mov_b32 v65, 0
    v_mov_b32 v66, 0
    v_mov_b32 v67, 0
    v_mov_b32 v68, 0
    v_mov_b32 v69, 0
    v_mov_b32 v70, 0
    v_mov_b32 v71, 0
    v_mov_b32 v72, 0
    v_mov_b32 v73, 0
    v_mov_b32 v74, 0
    v_mov_b32 v75, 0
    v_mov_b32 v76, 0
    v_mov_b32 v77, 0
    v_mov_b32 v78, 0
    v_mov_b32 v79, 0
    s_waitcnt vmcnt(17) lgkmcnt(0)
    s_barrier
    s_add_u32 s62, s58, s61
    s_and_b32 s62, s62, 15
    s_lshl_b32 s62, s62, 6
    s_add_u32 s61, s61, 1
    v_xor_b32 v10, s62, v9
    ds_read_b128 v[224:227], v10
    ds_read_b128 v[228:231], v10 offset:16384
    s_mov_b32 s64, 0
L_q_loop:
    s_add_u32 s60, s58, s59
    s_and_b32 s60, s60, 15
    s_lshl_b32 s60, s60, 18
    s_add_u32 s59, s59, 1
    s_add_u32 s62, s58, s61
    s_and_b32 s62, s62, 15
    s_lshl_b32 s62, s62, 6
    s_add_u32 s61, s61, 1
    v_xor_b32 v10, s62, v9
    ds_read_b128 v[232:235], v10
    ds_read_b128 v[236:239], v10 offset:16384
    s_waitcnt vmcnt(16) lgkmcnt(2)
    v_perm_b32 v208, v84, v80, s56
    v_perm_b32 v209, v92, v88, s56
    v_perm_b32 v210, v100, v96, s56
    v_perm_b32 v211, v108, v104, s56
    v_perm_b32 v212, v84, v80, s57
    v_perm_b32 v213, v92, v88, s57
    v_perm_b32 v214, v100, v96, s57
    v_perm_b32 v215, v108, v104, s57
    v_mfma_f32_16x16x32_bf16 v[16:19], v[208:211], v[224:227], v[16:19]
    buffer_load_dwordx4 v[176:179], v1, s[24:27], s60 offen
    v_perm_b32 v216, v85, v81, s56
    v_perm_b32 v217, v93, v89, s56
    v_mfma_f32_16x16x32_bf16 v[20:23], v[208:211], v[228:231], v[20:23]
    v_perm_b32 v218, v101, v97, s56
    v_perm_b32 v219, v109, v105, s56
    v_mfma_f32_16x16x32_bf16 v[24:27], v[212:215], v[224:227], v[24:27]
    buffer_load_dwordx4 v[180:183], v2, s[24:27], s60 offen
    v_perm_b32 v220, v85, v81, s57
    v_perm_b32 v221, v93, v89, s57
    v_mfma_f32_16x16x32_bf16 v[28:31], v[212:215], v[228:231], v[28:31]
    v_perm_b32 v222, v101, v97, s57
    v_perm_b32 v223, v109, v105, s57
    v_mfma_f32_16x16x32_bf16 v[32:35], v[216:219], v[224:227], v[32:35]
    buffer_load_dwordx4 v[184:187], v3, s[24:27], s60 offen
    v_perm_b32 v208, v86, v82, s56
    v_perm_b32 v209, v94, v90, s56
    v_mfma_f32_16x16x32_bf16 v[36:39], v[216:219], v[228:231], v[36:39]
    v_perm_b32 v210, v102, v98, s56
    v_perm_b32 v211, v110, v106, s56
    v_mfma_f32_16x16x32_bf16 v[40:43], v[220:223], v[224:227], v[40:43]
    buffer_load_dwordx4 v[188:191], v4, s[24:27], s60 offen
    v_perm_b32 v212, v86, v82, s57
    v_perm_b32 v213, v94, v90, s57
    v_mfma_f32_16x16x32_bf16 v[44:47], v[220:223], v[228:231], v[44:47]
    v_perm_b32 v214, v102, v98, s57
    v_perm_b32 v215, v110, v106, s57
    v_mfma_f32_16x16x32_bf16 v[48:51], v[208:211], v[224:227], v[48:51]
    buffer_load_dwordx4 v[192:195], v5, s[24:27], s60 offen
    v_perm_b32 v216, v87, v83, s56
    v_perm_b32 v217, v95, v91, s56
    v_mfma_f32_16x16x32_bf16 v[52:55], v[208:211], v[228:231], v[52:55]
    v_perm_b32 v218, v103, v99, s56
    v_perm_b32 v219, v111, v107, s56
    v_mfma_f32_16x16x32_bf16 v[56:59], v[212:215], v[224:227], v[56:59]
    buffer_load_dwordx4 v[196:199], v6, s[24:27], s60 offen
    v_perm_b32 v220, v87, v83, s57
    v_perm_b32 v221, v95, v91, s57
    v_mfma_f32_16x16x32_bf16 v[60:63], v[212:215], v[228:231], v[60:63]
    v_perm_b32 v222, v103, v99, s57
    v_perm_b32 v223, v111, v107, s57
    v_mfma_f32_16x16x32_bf16 v[64:67], v[216:219], v[224:227], v[64:67]
    buffer_load_dwordx4 v[200:203], v7, s[24:27], s60 offen
    v_mfma_f32_16x16x32_bf16 v[68:71], v[216:219], v[228:231], v[68:71]
    v_mfma_f32_16x16x32_bf16 v[72:75], v[220:223], v[224:227], v[72:75]
    buffer_load_dwordx4 v[204:207], v8, s[24:27], s60 offen
    v_mfma_f32_16x16x32_bf16 v[76:79], v[220:223], v[228:231], v[76:79]
    s_add_u32 s60, s58, s59
    s_and_b32 s60, s60, 15
    s_lshl_b32 s60, s60, 18
    s_add_u32 s59, s59, 1
    s_add_u32 s62, s58, s61
    s_and_b32 s62, s62, 15
    s_lshl_b32 s62, s62, 6
    s_add_u32 s61, s61, 1
    v_xor_b32 v10, s62, v9
    ds_read_b128 v[224:227], v10
    ds_read_b128 v[228:231], v10 offset:16384
    s_waitcnt vmcnt(16) lgkmcnt(2)
    v_perm_b32 v208, v116, v112, s56
    v_perm_b32 v209, v124, v120, s56
    v_perm_b32 v210, v132, v128, s56
    v_perm_b32 v211, v140, v136, s56
    v_perm_b32 v212, v116, v112, s57
    v_perm_b32 v213, v124, v120, s57
    v_perm_b32 v214, v132, v128, s57
    v_perm_b32 v215, v140, v136, s57
    v_mfma_f32_16x16x32_bf16 v[16:19], v[208:211], v[232:235], v[16:19]
    buffer_load_dwordx4 v[80:83], v1, s[24:27], s60 offen
    v_perm_b32 v216, v117, v113, s56
    v_perm_b32 v217, v125, v121, s56
    v_mfma_f32_16x16x32_bf16 v[20:23], v[208:211], v[236:239], v[20:23]
    v_perm_b32 v218, v133, v129, s56
    v_perm_b32 v219, v141, v137, s56
    v_mfma_f32_16x16x32_bf16 v[24:27], v[212:215], v[232:235], v[24:27]
    buffer_load_dwordx4 v[84:87], v2, s[24:27], s60 offen
    v_perm_b32 v220, v117, v113, s57
    v_perm_b32 v221, v125, v121, s57
    v_mfma_f32_16x16x32_bf16 v[28:31], v[212:215], v[236:239], v[28:31]
    v_perm_b32 v222, v133, v129, s57
    v_perm_b32 v223, v141, v137, s57
    v_mfma_f32_16x16x32_bf16 v[32:35], v[216:219], v[232:235], v[32:35]
    buffer_load_dwordx4 v[88:91], v3, s[24:27], s60 offen
    v_perm_b32 v208, v118, v114, s56
    v_perm_b32 v209, v126, v122, s56
    v_mfma_f32_16x16x32_bf16 v[36:39], v[216:219], v[236:239], v[36:39]
    v_perm_b32 v210, v134, v130, s56
    v_perm_b32 v211, v142, v138, s56
    v_mfma_f32_16x16x32_bf16 v[40:43], v[220:223], v[232:235], v[40:43]
    buffer_load_dwordx4 v[92:95], v4, s[24:27], s60 offen
    v_perm_b32 v212, v118, v114, s57
    v_perm_b32 v213, v126, v122, s57
    v_mfma_f32_16x16x32_bf16 v[44:47], v[220:223], v[236:239], v[44:47]
    v_perm_b32 v214, v134, v130, s57
    v_perm_b32 v215, v142, v138, s57
    v_mfma_f32_16x16x32_bf16 v[48:51], v[208:211], v[232:235], v[48:51]
    buffer_load_dwordx4 v[96:99], v5, s[24:27], s60 offen
    v_perm_b32 v216, v119, v115, s56
    v_perm_b32 v217, v127, v123, s56
    v_mfma_f32_16x16x32_bf16 v[52:55], v[208:211], v[236:239], v[52:55]
    v_perm_b32 v218, v135, v131, s56
    v_perm_b32 v219, v143, v139, s56
    v_mfma_f32_16x16x32_bf16 v[56:59], v[212:215], v[232:235], v[56:59]
    buffer_load_dwordx4 v[100:103], v6, s[24:27], s60 offen
    v_perm_b32 v220, v119, v115, s57
    v_perm_b32 v221, v127, v123, s57
    v_mfma_f32_16x16x32_bf16 v[60:63], v[212:215], v[236:239], v[60:63]
    v_perm_b32 v222, v135, v131, s57
    v_perm_b32 v223, v143, v139, s57
    v_mfma_f32_16x16x32_bf16 v[64:67], v[216:219], v[232:235], v[64:67]
    buffer_load_dwordx4 v[104:107], v7, s[24:27], s60 offen
    v_mfma_f32_16x16x32_bf16 v[68:71], v[216:219], v[236:239], v[68:71]
    v_mfma_f32_16x16x32_bf16 v[72:75], v[220:223], v[232:235], v[72:75]
    buffer_load_dwordx4 v[108:111], v8, s[24:27], s60 offen
    v_mfma_f32_16x16x32_bf16 v[76:79], v[220:223], v[236:239], v[76:79]
    s_add_u32 s60, s58, s59
    s_and_b32 s60, s60, 15
    s_lshl_b32 s60, s60, 18
    s_add_u32 s59, s59, 1
    s_add_u32 s62, s58, s61
    s_and_b32 s62, s62, 15
    s_lshl_b32 s62, s62, 6
    s_add_u32 s61, s61, 1
    v_xor_b32 v10, s62, v9
    ds_read_b128 v[232:235], v10
    ds_read_b128 v[236:239], v10 offset:16384
    s_waitcnt vmcnt(16) lgkmcnt(2)
    v_perm_b32 v208, v148, v144, s56
    v_perm_b32 v209, v156, v152, s56
    v_perm_b32 v210, v164, v160, s56
    v_perm_b32 v211, v172, v168, s56
    v_perm_b32 v212, v148, v144, s57
    v_perm_b32 v213, v156, v152, s57
    v_perm_b32 v214, v164, v160, s57
    v_perm_b32 v215, v172, v168, s57
    v_mfma_f32_16x16x32_bf16 v[16:19], v[208:211], v[224:227], v[16:19]
    buffer_load_dwordx4 v[112:115], v1, s[24:27], s60 offen
    v_perm_b32 v216, v149, v145, s56
    v_perm_b32 v217, v157, v153, s56
    v_mfma_f32_16x16x32_bf16 v[20:23], v[208:211], v[228:231], v[20:23]
    v_perm_b32 v218, v165, v161, s56
    v_perm_b32 v219, v173, v169, s56
    v_mfma_f32_16x16x32_bf16 v[24:27], v[212:215], v[224:227], v[24:27]
    buffer_load_dwordx4 v[116:119], v2, s[24:27], s60 offen
    v_perm_b32 v220, v149, v145, s57
    v_perm_b32 v221, v157, v153, s57
    v_mfma_f32_16x16x32_bf16 v[28:31], v[212:215], v[228:231], v[28:31]
    v_perm_b32 v222, v165, v161, s57
    v_perm_b32 v223, v173, v169, s57
    v_mfma_f32_16x16x32_bf16 v[32:35], v[216:219], v[224:227], v[32:35]
    buffer_load_dwordx4 v[120:123], v3, s[24:27], s60 offen
    v_perm_b32 v208, v150, v146, s56
    v_perm_b32 v209, v158, v154, s56
    v_mfma_f32_16x16x32_bf16 v[36:39], v[216:219], v[228:231], v[36:39]
    v_perm_b32 v210, v166, v162, s56
    v_perm_b32 v211, v174, v170, s56
    v_mfma_f32_16x16x32_bf16 v[40:43], v[220:223], v[224:227], v[40:43]
    buffer_load_dwordx4 v[124:127], v4, s[24:27], s60 offen
    v_perm_b32 v212, v150, v146, s57
    v_perm_b32 v213, v158, v154, s57
    v_mfma_f32_16x16x32_bf16 v[44:47], v[220:223], v[228:231], v[44:47]
    v_perm_b32 v214, v166, v162, s57
    v_perm_b32 v215, v174, v170, s57
    v_mfma_f32_16x16x32_bf16 v[48:51], v[208:211], v[224:227], v[48:51]
    buffer_load_dwordx4 v[128:131], v5, s[24:27], s60 offen
    v_perm_b32 v216, v151, v147, s56
    v_perm_b32 v217, v159, v155, s56
    v_mfma_f32_16x16x32_bf16 v[52:55], v[208:211], v[228:231], v[52:55]
    v_perm_b32 v218, v167, v163, s56
    v_perm_b32 v219, v175, v171, s56
    v_mfma_f32_16x16x32_bf16 v[56:59], v[212:215], v[224:227], v[56:59]
    buffer_load_dwordx4 v[132:135], v6, s[24:27], s60 offen
    v_perm_b32 v220, v151, v147, s57
    v_perm_b32 v221, v159, v155, s57
    v_mfma_f32_16x16x32_bf16 v[60:63], v[212:215], v[228:231], v[60:63]
    v_perm_b32 v222, v167, v163, s57
    v_perm_b32 v223, v175, v171, s57
    v_mfma_f32_16x16x32_bf16 v[64:67], v[216:219], v[224:227], v[64:67]
    buffer_load_dwordx4 v[136:139], v7, s[24:27], s60 offen
    v_mfma_f32_16x16x32_bf16 v[68:71], v[216:219], v[228:231], v[68:71]
    v_mfma_f32_16x16x32_bf16 v[72:75], v[220:223], v[224:227], v[72:75]
    buffer_load_dwordx4 v[140:143], v8, s[24:27], s60 offen
    v_mfma_f32_16x16x32_bf16 v[76:79], v[220:223], v[228:231], v[76:79]
    s_add_u32 s60, s58, s59
    s_and_b32 s60, s60, 15
    s_lshl_b32 s60, s60, 18
    s_add_u32 s59, s59, 1
    s_add_u32 s62, s58, s61
    s_and_b32 s62, s62, 15
    s_lshl_b32 s62, s62, 6
    s_add_u32 s61, s61, 1
    v_xor_b32 v10, s62, v9
    ds_read_b128 v[224:227], v10
    ds_read_b128 v[228:231], v10 offset:16384
    s_waitcnt vmcnt(16) lgkmcnt(2)
    v_perm_b32 v208, v180, v176, s56
    v_perm_b32 v209, v188, v184, s56
    v_perm_b32 v210, v196, v192, s56
    v_perm_b32 v211, v204, v200, s56
    v_perm_b32 v212, v180, v176, s57
    v_perm_b32 v213, v188, v184, s57
    v_perm_b32 v214, v196, v192, s57
    v_perm_b32 v215, v204, v200, s57
    v_mfma_f32_16x16x32_bf16 v[16:19], v[208:211], v[232:235], v[16:19]
    buffer_load_dwordx4 v[144:147], v1, s[24:27], s60 offen
    v_perm_b32 v216, v181, v177, s56
    v_perm_b32 v217, v189, v185, s56
    v_mfma_f32_16x16x32_bf16 v[20:23], v[208:211], v[236:239], v[20:23]
    v_perm_b32 v218, v197, v193, s56
    v_perm_b32 v219, v205, v201, s56
    v_mfma_f32_16x16x32_bf16 v[24:27], v[212:215], v[232:235], v[24:27]
    buffer_load_dwordx4 v[148:151], v2, s[24:27], s60 offen
    v_perm_b32 v220, v181, v177, s57
    v_perm_b32 v221, v189, v185, s57
    v_mfma_f32_16x16x32_bf16 v[28:31], v[212:215], v[236:239], v[28:31]
    v_perm_b32 v222, v197, v193, s57
    v_perm_b32 v223, v205, v201, s57
    v_mfma_f32_16x16x32_bf16 v[32:35], v[216:219], v[232:235], v[32:35]
    buffer_load_dwordx4 v[152:155], v3, s[24:27], s60 offen
    v_perm_b32 v208, v182, v178, s56
    v_perm_b32 v209, v190, v186, s56
    v_mfma_f32_16x16x32_bf16 v[36:39], v[216:219], v[236:239], v[36:39]
    v_perm_b32 v210, v198, v194, s56
    v_perm_b32 v211, v206, v202, s56
    v_mfma_f32_16x16x32_bf16 v[40:43], v[220:223], v[232:235], v[40:43]
    buffer_load_dwordx4 v[156:159], v4, s[24:27], s60 offen
    v_perm_b32 v212, v182, v178, s57
    v_perm_b32 v213, v190, v186, s57
    v_mfma_f32_16x16x32_bf16 v[44:47], v[220:223], v[236:239], v[44:47]
    v_perm_b32 v214, v198, v194, s57
    v_perm_b32 v215, v206, v202, s57
    v_mfma_f32_16x16x32_bf16 v[48:51], v[208:211], v[232:235], v[48:51]
    buffer_load_dwordx4 v[160:163], v5, s[24:27], s60 offen
    v_perm_b32 v216, v183, v179, s56
    v_perm_b32 v217, v191, v187, s56
    v_mfma_f32_16x16x32_bf16 v[52:55], v[208:211], v[236:239], v[52:55]
    v_perm_b32 v218, v199, v195, s56
    v_perm_b32 v219, v207, v203, s56
    v_mfma_f32_16x16x32_bf16 v[56:59], v[212:215], v[232:235], v[56:59]
    buffer_load_dwordx4 v[164:167], v6, s[24:27], s60 offen
    v_perm_b32 v220, v183, v179, s57
    v_perm_b32 v221, v191, v187, s57
    v_mfma_f32_16x16x32_bf16 v[60:63], v[212:215], v[236:239], v[60:63]
    v_perm_b32 v222, v199, v195, s57
    v_perm_b32 v223, v207, v203, s57
    v_mfma_f32_16x16x32_bf16 v[64:67], v[216:219], v[232:235], v[64:67]
    buffer_load_dwordx4 v[168:171], v7, s[24:27], s60 offen
    v_mfma_f32_16x16x32_bf16 v[68:71], v[216:219], v[236:239], v[68:71]
    v_mfma_f32_16x16x32_bf16 v[72:75], v[220:223], v[232:235], v[72:75]
    buffer_load_dwordx4 v[172:175], v8, s[24:27], s60 offen
    v_mfma_f32_16x16x32_bf16 v[76:79], v[220:223], v[236:239], v[76:79]
    s_add_u32 s64, s64, 1
    s_cmp_lt_u32 s64, 3
    s_cbranch_scc1 L_q_loop
    s_add_u32 s60, s58, s59
    s_and_b32 s60, s60, 15
    s_lshl_b32 s60, s60, 18
    s_add_u32 s59, s59, 1
    s_add_u32 s62, s58, s61
    s_and_b32 s62, s62, 15
    s_lshl_b32 s62, s62, 6
    s_add_u32 s61, s61, 1
    v_xor_b32 v10, s62, v9
    ds_read_b128 v[232:235], v10
    ds_read_b128 v[236:239], v10 offset:16384
    s_waitcnt vmcnt(16) lgkmcnt(2)
    v_perm_b32 v208, v84, v80, s56
    v_perm_b32 v209, v92, v88, s56
    v_perm_b32 v210, v100, v96, s56
    v_perm_b32 v211, v108, v104, s56
    v_perm_b32 v212, v84, v80, s57
    v_perm_b32 v213, v92, v88, s57
    v_perm_b32 v214, v100, v96, s57
    v_perm_b32 v215, v108, v104, s57
    v_mfma_f32_16x16x32_bf16 v[16:19], v[208:211], v[224:227], v[16:19]
    buffer_load_dwordx4 v[176:179], v1, s[24:27], s60 offen
    v_perm_b32 v216, v85, v81, s56
    v_perm_b32 v217, v93, v89, s56
    v_mfma_f32_16x16x32_bf16 v[20:23], v[208:211], v[228:231], v[20:23]
    v_perm_b32 v218, v101, v97, s56
    v_perm_b32 v219, v109, v105, s56
    v_mfma_f32_16x16x32_bf16 v[24:27], v[212:215], v[224:227], v[24:27]
    buffer_load_dwordx4 v[180:183], v2, s[24:27], s60 offen
    v_perm_b32 v220, v85, v81, s57
    v_perm_b32 v221, v93, v89, s57
    v_mfma_f32_16x16x32_bf16 v[28:31], v[212:215], v[228:231], v[28:31]
    v_perm_b32 v222, v101, v97, s57
    v_perm_b32 v223, v109, v105, s57
    v_mfma_f32_16x16x32_bf16 v[32:35], v[216:219], v[224:227], v[32:35]
    buffer_load_dwordx4 v[184:187], v3, s[24:27], s60 offen
    v_perm_b32 v208, v86, v82, s56
    v_perm_b32 v209, v94, v90, s56
    v_mfma_f32_16x16x32_bf16 v[36:39], v[216:219], v[228:231], v[36:39]
    v_perm_b32 v210, v102, v98, s56
    v_perm_b32 v211, v110, v106, s56
    v_mfma_f32_16x16x32_bf16 v[40:43], v[220:223], v[224:227], v[40:43]
    buffer_load_dwordx4 v[188:191], v4, s[24:27], s60 offen
    v_perm_b32 v212, v86, v82, s57
    v_perm_b32 v213, v94, v90, s57
    v_mfma_f32_16x16x32_bf16 v[44:47], v[220:223], v[228:231], v[44:47]
    v_perm_b32 v214, v102, v98, s57
    v_perm_b32 v215, v110, v106, s57
    v_mfma_f32_16x16x32_bf16 v[48:51], v[208:211], v[224:227], v[48:51]
    buffer_load_dwordx4 v[192:195], v5, s[24:27], s60 offen
    v_perm_b32 v216, v87, v83, s56
    v_perm_b32 v217, v95, v91, s56
    v_mfma_f32_16x16x32_bf16 v[52:55], v[208:211], v[228:231], v[52:55]
    v_perm_b32 v218, v103, v99, s56
    v_perm_b32 v219, v111, v107, s56
    v_mfma_f32_16x16x32_bf16 v[56:59], v[212:215], v[224:227], v[56:59]
    buffer_load_dwordx4 v[196:199], v6, s[24:27], s60 offen
    v_perm_b32 v220, v87, v83, s57
    v_perm_b32 v221, v95, v91, s57
    v_mfma_f32_16x16x32_bf16 v[60:63], v[212:215], v[228:231], v[60:63]
    v_perm_b32 v222, v103, v99, s57
    v_perm_b32 v223, v111, v107, s57
    v_mfma_f32_16x16x32_bf16 v[64:67], v[216:219], v[224:227], v[64:67]
    buffer_load_dwordx4 v[200:203], v7, s[24:27], s60 offen
    v_mfma_f32_16x16x32_bf16 v[68:71], v[216:219], v[228:231], v[68:71]
    v_mfma_f32_16x16x32_bf16 v[72:75], v[220:223], v[224:227], v[72:75]
    buffer_load_dwordx4 v[204:207], v8, s[24:27], s60 offen
    v_mfma_f32_16x16x32_bf16 v[76:79], v[220:223], v[228:231], v[76:79]
    v_mov_b32 v15, 1
    ds_write_b32 v14, v15
    s_add_u32 s62, s58, s61
    s_and_b32 s62, s62, 15
    s_lshl_b32 s62, s62, 6
    s_add_u32 s61, s61, 1
    v_xor_b32 v10, s62, v9
    ds_read_b128 v[224:227], v10
    ds_read_b128 v[228:231], v10 offset:16384
    s_waitcnt vmcnt(16) lgkmcnt(2)
    v_perm_b32 v208, v116, v112, s56
    v_perm_b32 v209, v124, v120, s56
    v_perm_b32 v210, v132, v128, s56
    v_perm_b32 v211, v140, v136, s56
    v_perm_b32 v212, v116, v112, s57
    v_perm_b32 v213, v124, v120, s57
    v_perm_b32 v214, v132, v128, s57
    v_perm_b32 v215, v140, v136, s57
    v_mfma_f32_16x16x32_bf16 v[16:19], v[208:211], v[232:235], v[16:19]
    v_perm_b32 v216, v117, v113, s56
    v_perm_b32 v217, v125, v121, s56
    v_mfma_f32_16x16x32_bf16 v[20:23], v[208:211], v[236:239], v[20:23]
    v_perm_b32 v218, v133, v129, s56
    v_perm_b32 v219, v141, v137, s56
    v_mfma_f32_16x16x32_bf16 v[24:27], v[212:215], v[232:235], v[24:27]
    v_perm_b32 v220, v117, v113, s57
    v_perm_b32 v221, v125, v121, s57
    v_mfma_f32_16x16x32_bf16 v[28:31], v[212:215], v[236:239], v[28:31]
    v_perm_b32 v222, v133, v129, s57
    v_perm_b32 v223, v141, v137, s57
    v_mfma_f32_16x16x32_bf16 v[32:35], v[216:219], v[232:235], v[32:35]
    v_perm_b32 v208, v118, v114, s56
    v_perm_b32 v209, v126, v122, s56
    v_mfma_f32_16x16x32_bf16 v[36:39], v[216:219], v[236:239], v[36:39]
    v_perm_b32 v210, v134, v130, s56
    v_perm_b32 v211, v142, v138, s56
    v_mfma_f32_16x16x32_bf16 v[40:43], v[220:223], v[232:235], v[40:43]
    v_perm_b32 v212, v118, v114, s57
    v_perm_b32 v213, v126, v122, s57
    v_mfma_f32_16x16x32_bf16 v[44:47], v[220:223], v[236:239], v[44:47]
    v_perm_b32 v214, v134, v130, s57
    v_perm_b32 v215, v142, v138, s57
    v_mfma_f32_16x16x32_bf16 v[48:51], v[208:211], v[232:235], v[48:51]
    v_perm_b32 v216, v119, v115, s56
    v_perm_b32 v217, v127, v123, s56
    v_mfma_f32_16x16x32_bf16 v[52:55], v[208:211], v[236:239], v[52:55]
    v_perm_b32 v218, v135, v131, s56
    v_perm_b32 v219, v143, v139, s56
    v_mfma_f32_16x16x32_bf16 v[56:59], v[212:215], v[232:235], v[56:59]
    v_perm_b32 v220, v119, v115, s57
    v_perm_b32 v221, v127, v123, s57
    v_mfma_f32_16x16x32_bf16 v[60:63], v[212:215], v[236:239], v[60:63]
    v_perm_b32 v222, v135, v131, s57
    v_perm_b32 v223, v143, v139, s57
    v_mfma_f32_16x16x32_bf16 v[64:67], v[216:219], v[232:235], v[64:67]
    v_mfma_f32_16x16x32_bf16 v[68:71], v[216:219], v[236:239], v[68:71]
    v_mfma_f32_16x16x32_bf16 v[72:75], v[220:223], v[232:235], v[72:75]
    v_mfma_f32_16x16x32_bf16 v[76:79], v[220:223], v[236:239], v[76:79]
    s_add_u32 s62, s58, s61
    s_and_b32 s62, s62, 15
    s_lshl_b32 s62, s62, 6
    s_add_u32 s61, s61, 1
    v_xor_b32 v10, s62, v9
    ds_read_b128 v[232:235], v10
    ds_read_b128 v[236:239], v10 offset:16384
    s_waitcnt vmcnt(8) lgkmcnt(2)
    v_perm_b32 v208, v148, v144, s56
    v_perm_b32 v209, v156, v152, s56
    v_perm_b32 v210, v164, v160, s56
    v_perm_b32 v211, v172, v168, s56
    v_perm_b32 v212, v148, v144, s57
    v_perm_b32 v213, v156, v152, s57
    v_perm_b32 v214, v164, v160, s57
    v_perm_b32 v215, v172, v168, s57
    v_mfma_f32_16x16x32_bf16 v[16:19], v[208:211], v[224:227], v[16:19]
    v_perm_b32 v216, v149, v145, s56
    v_perm_b32 v217, v157, v153, s56
    v_mfma_f32_16x16x32_bf16 v[20:23], v[208:211], v[228:231], v[20:23]
    v_perm_b32 v218, v165, v161, s56
    v_perm_b32 v219, v173, v169, s56
    v_mfma_f32_16x16x32_bf16 v[24:27], v[212:215], v[224:227], v[24:27]
    v_perm_b32 v220, v149, v145, s57
    v_perm_b32 v221, v157, v153, s57
    v_mfma_f32_16x16x32_bf16 v[28:31], v[212:215], v[228:231], v[28:31]
    v_perm_b32 v222, v165, v161, s57
    v_perm_b32 v223, v173, v169, s57
    v_mfma_f32_16x16x32_bf16 v[32:35], v[216:219], v[224:227], v[32:35]
    v_perm_b32 v208, v150, v146, s56
    v_perm_b32 v209, v158, v154, s56
    v_mfma_f32_16x16x32_bf16 v[36:39], v[216:219], v[228:231], v[36:39]
    v_perm_b32 v210, v166, v162, s56
    v_perm_b32 v211, v174, v170, s56
    v_mfma_f32_16x16x32_bf16 v[40:43], v[220:223], v[224:227], v[40:43]
    v_perm_b32 v212, v150, v146, s57
    v_perm_b32 v213, v158, v154, s57
    v_mfma_f32_16x16x32_bf16 v[44:47], v[220:223], v[228:231], v[44:47]
    v_perm_b32 v214, v166, v162, s57
    v_perm_b32 v215, v174, v170, s57
    v_mfma_f32_16x16x32_bf16 v[48:51], v[208:211], v[224:227], v[48:51]
    v_perm_b32 v216, v151, v147, s56
    v_perm_b32 v217, v159, v155, s56
    v_mfma_f32_16x16x32_bf16 v[52:55], v[208:211], v[228:231], v[52:55]
    v_perm_b32 v218, v167, v163, s56
    v_perm_b32 v219, v175, v171, s56
    v_mfma_f32_16x16x32_bf16 v[56:59], v[212:215], v[224:227], v[56:59]
    v_perm_b32 v220, v151, v147, s57
    v_perm_b32 v221, v159, v155, s57
    v_mfma_f32_16x16x32_bf16 v[60:63], v[212:215], v[228:231], v[60:63]
    v_perm_b32 v222, v167, v163, s57
    v_perm_b32 v223, v175, v171, s57
    v_mfma_f32_16x16x32_bf16 v[64:67], v[216:219], v[224:227], v[64:67]
    v_mfma_f32_16x16x32_bf16 v[68:71], v[216:219], v[228:231], v[68:71]
    v_mfma_f32_16x16x32_bf16 v[72:75], v[220:223], v[224:227], v[72:75]
    v_mfma_f32_16x16x32_bf16 v[76:79], v[220:223], v[228:231], v[76:79]
    s_waitcnt vmcnt(0) lgkmcnt(0)
    v_perm_b32 v208, v180, v176, s56
    v_perm_b32 v209, v188, v184, s56
    v_perm_b32 v210, v196, v192, s56
    v_perm_b32 v211, v204, v200, s56
    v_perm_b32 v212, v180, v176, s57
    v_perm_b32 v213, v188, v184, s57
    v_perm_b32 v214, v196, v192, s57
    v_perm_b32 v215, v204, v200, s57
    v_mfma_f32_16x16x32_bf16 v[16:19], v[208:211], v[232:235], v[16:19]
    v_perm_b32 v216, v181, v177, s56
    v_perm_b32 v217, v189, v185, s56
    v_mfma_f32_16x16x32_bf16 v[20:23], v[208:211], v[236:239], v[20:23]
    v_perm_b32 v218, v197, v193, s56
    v_perm_b32 v219, v205, v201, s56
    v_mfma_f32_16x16x32_bf16 v[24:27], v[212:215], v[232:235], v[24:27]
    v_perm_b32 v220, v181, v177, s57
    v_perm_b32 v221, v189, v185, s57
    v_mfma_f32_16x16x32_bf16 v[28:31], v[212:215], v[236:239], v[28:31]
    v_perm_b32 v222, v197, v193, s57
    v_perm_b32 v223, v205, v201, s57
    v_mfma_f32_16x16x32_bf16 v[32:35], v[216:219], v[232:235], v[32:35]
    v_perm_b32 v208, v182, v178, s56
    v_perm_b32 v209, v190, v186, s56
    v_mfma_f32_16x16x32_bf16 v[36:39], v[216:219], v[236:239], v[36:39]
    v_perm_b32 v210, v198, v194, s56
    v_perm_b32 v211, v206, v202, s56
    v_mfma_f32_16x16x32_bf16 v[40:43], v[220:223], v[232:235], v[40:43]
    v_perm_b32 v212, v182, v178, s57
    v_perm_b32 v213, v190, v186, s57
    v_mfma_f32_16x16x32_bf16 v[44:47], v[220:223], v[236:239], v[44:47]
    v_perm_b32 v214, v198, v194, s57
    v_perm_b32 v215, v206, v202, s57
    v_mfma_f32_16x16x32_bf16 v[48:51], v[208:211], v[232:235], v[48:51]
    v_perm_b32 v216, v183, v179, s56
    v_perm_b32 v217, v191, v187, s56
    v_mfma_f32_16x16x32_bf16 v[52:55], v[208:211], v[236:239], v[52:55]
    v_perm_b32 v218, v199, v195, s56
    v_perm_b32 v219, v207, v203, s56
    v_mfma_f32_16x16x32_bf16 v[56:59], v[212:215], v[232:235], v[56:59]
    v_perm_b32 v220, v183, v179, s57
    v_perm_b32 v221, v191, v187, s57
    v_mfma_f32_16x16x32_bf16 v[60:63], v[212:215], v[236:239], v[60:63]
    v_perm_b32 v222, v199, v195, s57
    v_perm_b32 v223, v207, v203, s57
    v_mfma_f32_16x16x32_bf16 v[64:67], v[216:219], v[232:235], v[64:67]
    v_mfma_f32_16x16x32_bf16 v[68:71], v[216:219], v[236:239], v[68:71]
    v_mfma_f32_16x16x32_bf16 v[72:75], v[220:223], v[232:235], v[72:75]
    v_mfma_f32_16x16x32_bf16 v[76:79], v[220:223], v[236:239], v[76:79]
    v_mov_b32 v4, v13
    v_mov_b32 v5, v14
    v_mov_b32 v3, 2
    ds_write_b32 v5, v3
    ds_read_b32 v6, v4
    s_mov_b32 s67, 0x3e0293ee
    s_mov_b32 s68, 0x41c00000
    v_mov_b32 v7, v0
    v_and_b32 v1, 31, v0
    v_lshrrev_b32 v2, 5, v0
    v_lshlrev_b32 v2, 3, v2
    v_and_b32 v0, 15, v0
    v_xor_b32 v2, v2, v0
    v_lshlrev_b32 v2, 4, v2
    v_lshl_add_u32 v2, v1, 8, v2
    v_xor_b32 v8, 0, v2
    v_xor_b32 v9, 16, v2
    v_xor_b32 v10, 32, v2
    v_xor_b32 v11, 48, v2
    v_xor_b32 v12, 64, v2
    v_xor_b32 v13, 80, v2
    v_xor_b32 v14, 96, v2
    v_xor_b32 v15, 112, v2
    v_mov_b32 v2, s67
    v_mul_f32 v16, v2, v16
    v_mul_f32 v17, v2, v17
    v_mul_f32 v18, v2, v18
    v_mul_f32 v19, v2, v19
    v_mul_f32 v20, v2, v20
    v_mul_f32 v21, v2, v21
    v_mul_f32 v22, v2, v22
    v_mul_f32 v23, v2, v23
    v_mul_f32 v24, v2, v24
    v_mul_f32 v25, v2, v25
    v_mul_f32 v26, v2, v26
    v_mul_f32 v27, v2, v27
    v_mul_f32 v28, v2, v28
    v_mul_f32 v29, v2, v29
    v_mul_f32 v30, v2, v30
    v_mul_f32 v31, v2, v31
    v_mul_f32 v32, v2, v32
    v_mul_f32 v33, v2, v33
    v_mul_f32 v34, v2, v34
    v_mul_f32 v35, v2, v35
    v_mul_f32 v36, v2, v36
    v_mul_f32 v37, v2, v37
    v_mul_f32 v38, v2, v38
    v_mul_f32 v39, v2, v39
    v_mul_f32 v40, v2, v40
    v_mul_f32 v41, v2, v41
    v_mul_f32 v42, v2, v42
    v_mul_f32 v43, v2, v43
    v_mul_f32 v44, v2, v44
    v_mul_f32 v45, v2, v45
    v_mul_f32 v46, v2, v46
    v_mul_f32 v47, v2, v47
    v_mul_f32 v48, v2, v48
    v_mul_f32 v49, v2, v49
    v_mul_f32 v50, v2, v50
    v_mul_f32 v51, v2, v51
    v_mul_f32 v52, v2, v52
    v_mul_f32 v53, v2, v53
    v_mul_f32 v54, v2, v54
    v_mul_f32 v55, v2, v55
    v_mul_f32 v56, v2, v56
    v_mul_f32 v57, v2, v57
    v_mul_f32 v58, v2, v58
    v_mul_f32 v59, v2, v59
    v_mul_f32 v60, v2, v60
    v_mul_f32 v61, v2, v61
    v_mul_f32 v62, v2, v62
    v_mul_f32 v63, v2, v63
    v_mul_f32 v64, v2, v64
    v_mul_f32 v65, v2, v65
    v_mul_f32 v66, v2, v66
    v_mul_f32 v67, v2, v67
    v_mul_f32 v68, v2, v68
    v_mul_f32 v69, v2, v69
    v_mul_f32 v70, v2, v70
    v_mul_f32 v71, v2, v71
    v_mul_f32 v72, v2, v72
    v_mul_f32 v73, v2, v73
    v_mul_f32 v74, v2, v74
    v_mul_f32 v75, v2, v75
    v_mul_f32 v76, v2, v76
    v_mul_f32 v77, v2, v77
    v_mul_f32 v78, v2, v78
    v_mul_f32 v79, v2, v79
    v_cvt_pk_bf16_f32 v96, v16, v24
    v_cvt_pk_bf16_f32 v97, v32, v40
    v_cvt_pk_bf16_f32 v98, v48, v56
    v_cvt_pk_bf16_f32 v99, v64, v72
    v_cvt_pk_bf16_f32 v100, v17, v25
    v_cvt_pk_bf16_f32 v101, v33, v41
    v_cvt_pk_bf16_f32 v102, v49, v57
    v_cvt_pk_bf16_f32 v103, v65, v73
    v_cvt_pk_bf16_f32 v104, v18, v26
    v_cvt_pk_bf16_f32 v105, v34, v42
    v_cvt_pk_bf16_f32 v106, v50, v58
    v_cvt_pk_bf16_f32 v107, v66, v74
    v_cvt_pk_bf16_f32 v108, v19, v27
    v_cvt_pk_bf16_f32 v109, v35, v43
    v_cvt_pk_bf16_f32 v110, v51, v59
    v_cvt_pk_bf16_f32 v111, v67, v75
    v_cvt_pk_bf16_f32 v112, v20, v28
    v_cvt_pk_bf16_f32 v113, v36, v44
    v_cvt_pk_bf16_f32 v114, v52, v60
    v_cvt_pk_bf16_f32 v115, v68, v76
    v_cvt_pk_bf16_f32 v116, v21, v29
    v_cvt_pk_bf16_f32 v117, v37, v45
    v_cvt_pk_bf16_f32 v118, v53, v61
    v_cvt_pk_bf16_f32 v119, v69, v77
    v_cvt_pk_bf16_f32 v120, v22, v30
    v_cvt_pk_bf16_f32 v121, v38, v46
    v_cvt_pk_bf16_f32 v122, v54, v62
    v_cvt_pk_bf16_f32 v123, v70, v78
    v_cvt_pk_bf16_f32 v124, v23, v31
    v_cvt_pk_bf16_f32 v125, v39, v47
    v_cvt_pk_bf16_f32 v126, v55, v63
    v_cvt_pk_bf16_f32 v127, v71, v79
    s_waitcnt lgkmcnt(0)
    v_cmp_gt_u32 vcc, 1, v6
    v_permlane16_swap_b32 v96, v112
    v_permlane16_swap_b32 v97, v113
    v_permlane16_swap_b32 v98, v114
    v_permlane16_swap_b32 v99, v115
    v_permlane16_swap_b32 v100, v116
    v_permlane16_swap_b32 v101, v117
    v_permlane16_swap_b32 v102, v118
    v_permlane16_swap_b32 v103, v119
    v_permlane16_swap_b32 v104, v120
    v_permlane16_swap_b32 v105, v121
    v_permlane16_swap_b32 v106, v122
    v_permlane16_swap_b32 v107, v123
    v_permlane16_swap_b32 v108, v124
    v_permlane16_swap_b32 v109, v125
    v_permlane16_swap_b32 v110, v126
    v_permlane16_swap_b32 v111, v127
    s_cbranch_vccnz L_sp_k0
L_ok_k0:
    ds_read_b128 v[16:19], v8 offset:0
    ds_read_b128 v[20:23], v9 offset:0
    ds_read_b128 v[24:27], v10 offset:0
    ds_read_b128 v[28:31], v11 offset:0
    ds_read_b128 v[32:35], v12 offset:0
    ds_read_b128 v[36:39], v13 offset:0
    ds_read_b128 v[40:43], v14 offset:0
    ds_read_b128 v[44:47], v15 offset:0
    ds_read_b32 v6, v4
    s_waitcnt lgkmcnt(7)
    v_mfma_f32_32x32x16_bf16 v[64:79], v[16:19], v[96:99], 0
    ds_read_b128 v[16:19], v8 offset:8192
    v_mfma_f32_32x32x16_bf16 v[64:79], v[20:23], v[100:103], v[64:79]
    ds_read_b128 v[20:23], v9 offset:8192
    s_waitcnt lgkmcnt(7)
    v_mfma_f32_32x32x16_bf16 v[64:79], v[24:27], v[104:107], v[64:79]
    ds_read_b128 v[24:27], v10 offset:8192
    v_mfma_f32_32x32x16_bf16 v[64:79], v[28:31], v[108:111], v[64:79]
    ds_read_b128 v[28:31], v11 offset:8192
    s_waitcnt lgkmcnt(7)
    v_mfma_f32_32x32x16_bf16 v[64:79], v[32:35], v[112:115], v[64:79]
    ds_read_b128 v[32:35], v12 offset:8192
    v_mfma_f32_32x32x16_bf16 v[64:79], v[36:39], v[116:119], v[64:79]
    ds_read_b128 v[36:39], v13 offset:8192
    s_waitcnt lgkmcnt(7)
    v_mfma_f32_32x32x16_bf16 v[64:79], v[40:43], v[120:123], v[64:79]
    ds_read_b128 v[40:43], v14 offset:8192
    v_mfma_f32_32x32x16_bf16 v[64:79], v[44:47], v[124:127], v[64:79]
    ds_read_b128 v[44:47], v15 offset:8192
    s_waitcnt lgkmcnt(8)
    v_cmp_gt_u32 vcc, 2, v6
    s_nop 7
    s_nop 2
    v_max3_f32 v0, v64, v65, v66
    v_max3_f32 v0, v0, v67, v68
    v_max3_f32 v0, v0, v69, v70
    v_max3_f32 v0, v0, v71, v72
    v_max3_f32 v0, v0, v73, v74
    v_max3_f32 v0, v0, v75, v76
    v_max3_f32 v0, v0, v77, v78
    v_max_f32 v0, v0, v79
    v_mov_b32 v1, v0
    s_nop 1
    v_permlane32_swap_b32 v0, v1
    v_max_f32 v0, v0, v1
    v_ceil_f32 v0, v0
    v_sub_f32 v64, v64, v0
    v_sub_f32 v65, v65, v0
    v_sub_f32 v66, v66, v0
    v_sub_f32 v67, v67, v0
    v_sub_f32 v68, v68, v0
    v_sub_f32 v69, v69, v0
    v_sub_f32 v70, v70, v0
    v_sub_f32 v71, v71, v0
    v_sub_f32 v72, v72, v0
    v_sub_f32 v73, v73, v0
    v_sub_f32 v74, v74, v0
    v_sub_f32 v75, v75, v0
    v_sub_f32 v76, v76, v0
    v_sub_f32 v77, v77, v0
    v_sub_f32 v78, v78, v0
    v_sub_f32 v79, v79, v0
    v_sub_f32 v1, 0, v0
    v_mov_b32 v48, v1
    v_mov_b32 v49, v1
    v_mov_b32 v50, v1
    v_mov_b32 v51, v1
    v_mov_b32 v52, v1
    v_mov_b32 v53, v1
    v_mov_b32 v54, v1
    v_mov_b32 v55, v1
    v_mov_b32 v56, v1
    v_mov_b32 v57, v1
    v_mov_b32 v58, v1
    v_mov_b32 v59, v1
    v_mov_b32 v60, v1
    v_mov_b32 v61, v1
    v_mov_b32 v62, v1
    v_mov_b32 v63, v1
    s_nop 1
    s_cbranch_vccnz L_sp_k1
L_ok_k1:
    s_waitcnt lgkmcnt(6)
    v_mfma_f32_32x32x16_bf16 v[80:95], v[16:19], v[96:99], v[48:63]
    ds_read_b128 v[16:19], v8 offset:16384
    v_max3_f32 v0, v64, v65, v66
    v_max3_f32 v0, v0, v67, v68
    v_max3_f32 v0, v0, v69, v70
    v_mfma_f32_32x32x16_bf16 v[80:95], v[20:23], v[100:103], v[80:95]
    ds_read_b128 v[20:23], v9 offset:16384
    v_max3_f32 v0, v0, v71, v72
    v_max3_f32 v0, v0, v73, v74
    v_max3_f32 v0, v0, v75, v76
    s_waitcnt lgkmcnt(6)
    v_mfma_f32_32x32x16_bf16 v[80:95], v[24:27], v[104:107], v[80:95]
    ds_read_b128 v[24:27], v10 offset:16384
    v_max3_f32 v0, v0, v77, v78
    v_max_f32 v0, v0, v79
    v_cmp_lt_f32 vcc, s68, v0
    v_mfma_f32_32x32x16_bf16 v[80:95], v[28:31], v[108:111], v[80:95]
    ds_read_b128 v[28:31], v11 offset:16384
    s_cbranch_vccnz L_rare_0
L_back_0:
    v_exp_f32 v64, v64
    v_exp_f32 v65, v65
    v_exp_f32 v66, v66
    s_waitcnt lgkmcnt(6)
    v_mfma_f32_32x32x16_bf16 v[80:95], v[32:35], v[112:115], v[80:95]
    ds_read_b128 v[32:35], v12 offset:16384
    v_exp_f32 v67, v67
    v_exp_f32 v68, v68
    v_exp_f32 v69, v69
    v_mfma_f32_32x32x16_bf16 v[80:95], v[36:39], v[116:119], v[80:95]
    ds_read_b128 v[36:39], v13 offset:16384
    v_exp_f32 v70, v70
    v_exp_f32 v71, v71
    v_exp_f32 v72, v72
    s_waitcnt lgkmcnt(6)
    v_mfma_f32_32x32x16_bf16 v[80:95], v[40:43], v[120:123], v[80:95]
    ds_read_b128 v[40:43], v14 offset:16384
    v_exp_f32 v73, v73
    v_exp_f32 v74, v74
    v_exp_f32 v75, v75
    v_mfma_f32_32x32x16_bf16 v[80:95], v[44:47], v[124:127], v[80:95]
    ds_read_b128 v[44:47], v15 offset:16384
    v_mov_b32 v3, 3
    ds_write_b32 v5, v3
    v_exp_f32 v76, v76
    v_exp_f32 v77, v77
    v_exp_f32 v78, v78
    v_exp_f32 v79, v79
    v_cvt_pk_bf16_f32 v128, v64, v65
    v_cvt_pk_bf16_f32 v129, v66, v67
    v_cvt_pk_bf16_f32 v130, v68, v69
    v_cvt_pk_bf16_f32 v131, v70, v71
    v_cvt_pk_bf16_f32 v132, v72, v73
    v_cvt_pk_bf16_f32 v133, v74, v75
    v_cvt_pk_bf16_f32 v134, v76, v77
    v_cvt_pk_bf16_f32 v135, v78, v79
    s_waitcnt lgkmcnt(7)
    v_mfma_f32_32x32x16_bf16 v[64:79], v[16:19], v[96:99], v[48:63]
    ds_read_b128 v[16:19], v8 offset:24576
    v_max3_f32 v0, v80, v81, v82
    v_max3_f32 v0, v0, v83, v84
    v_max3_f32 v0, v0, v85, v86
    v_mfma_f32_32x32x16_bf16 v[64:79], v[20:23], v[100:103], v[64:79]
    ds_read_b128 v[20:23], v9 offset:24576
    ds_read_b32 v6, v4
    v_max3_f32 v0, v0, v87, v88
    v_max3_f32 v0, v0, v89, v90
    v_max3_f32 v0, v0, v91, v92
    s_waitcnt lgkmcnt(8)
    v_mfma_f32_32x32x16_bf16 v[64:79], v[24:27], v[104:107], v[64:79]
    ds_read_b128 v[24:27], v10 offset:24576
    v_max3_f32 v0, v0, v93, v94
    v_max_f32 v0, v0, v95
    v_cmp_lt_f32 vcc, s68, v0
    v_mfma_f32_32x32x16_bf16 v[64:79], v[28:31], v[108:111], v[64:79]
    ds_read_b128 v[28:31], v11 offset:24576
    s_cbranch_vccnz L_rare_1
L_back_1:
    v_exp_f32 v80, v80
    v_exp_f32 v81, v81
    v_exp_f32 v82, v82
    s_waitcnt lgkmcnt(8)
    v_mfma_f32_32x32x16_bf16 v[64:79], v[32:35], v[112:115], v[64:79]
    ds_read_b128 v[32:35], v12 offset:24576
    v_exp_f32 v83, v83
    v_exp_f32 v84, v84
    v_exp_f32 v85, v85
    v_mfma_f32_32x32x16_bf16 v[64:79], v[36:39], v[116:119], v[64:79]
    ds_read_b128 v[36:39], v13 offset:24576
    v_exp_f32 v86, v86
    v_exp_f32 v87, v87
    v_exp_f32 v88, v88
    s_waitcnt lgkmcnt(8)
    v_mfma_f32_32x32x16_bf16 v[64:79], v[40:43], v[120:123], v[64:79]
    ds_read_b128 v[40:43], v14 offset:24576
    v_exp_f32 v89, v89
    v_exp_f32 v90, v90
    v_exp_f32 v91, v91
    v_mfma_f32_32x32x16_bf16 v[64:79], v[44:47], v[124:127], v[64:79]
    ds_read_b128 v[44:47], v15 offset:24576
    v_exp_f32 v92, v92
    v_exp_f32 v93, v93
    v_exp_f32 v94, v94
    v_exp_f32 v95, v95
    v_cvt_pk_bf16_f32 v136, v80, v81
    v_cvt_pk_bf16_f32 v137, v82, v83
    v_cvt_pk_bf16_f32 v138, v84, v85
    v_cvt_pk_bf16_f32 v139, v86, v87
    v_cvt_pk_bf16_f32 v140, v88, v89
    v_cvt_pk_bf16_f32 v141, v90, v91
    v_cvt_pk_bf16_f32 v142, v92, v93
    v_cvt_pk_bf16_f32 v143, v94, v95
    s_waitcnt lgkmcnt(6)
    v_cmp_gt_u32 vcc, 3, v6
    s_cbranch_vccnz L_sp_k2
L_ok_k2:
    v_mfma_f32_32x32x16_bf16 v[80:95], v[16:19], v[96:99], v[48:63]
    ds_read_b128 v[16:19], v8 offset:32768
    v_max3_f32 v0, v64, v65, v66
    v_max3_f32 v0, v0, v67, v68
    v_max3_f32 v0, v0, v69, v70
    v_mfma_f32_32x32x16_bf16 v[80:95], v[20:23], v[100:103], v[80:95]
    ds_read_b128 v[20:23], v9 offset:32768
    v_max3_f32 v0, v0, v71, v72
    v_max3_f32 v0, v0, v73, v74
    v_max3_f32 v0, v0, v75, v76
    s_waitcnt lgkmcnt(6)
    v_mfma_f32_32x32x16_bf16 v[80:95], v[24:27], v[104:107], v[80:95]
    ds_read_b128 v[24:27], v10 offset:32768
    v_max3_f32 v0, v0, v77, v78
    v_max_f32 v0, v0, v79
    v_cmp_lt_f32 vcc, s68, v0
    v_mfma_f32_32x32x16_bf16 v[80:95], v[28:31], v[108:111], v[80:95]
    ds_read_b128 v[28:31], v11 offset:32768
    s_cbranch_vccnz L_rare_2
L_back_2:
    v_exp_f32 v64, v64
    v_exp_f32 v65, v65
    v_exp_f32 v66, v66
    s_waitcnt lgkmcnt(6)
    v_mfma_f32_32x32x16_bf16 v[80:95], v[32:35], v[112:115], v[80:95]
    ds_read_b128 v[32:35], v12 offset:32768
    v_exp_f32 v67, v67
    v_exp_f32 v68, v68
    v_exp_f32 v69, v69
    v_mfma_f32_32x32x16_bf16 v[80:95], v[36:39], v[116:119], v[80:95]
    ds_read_b128 v[36:39], v13 offset:32768
    v_exp_f32 v70, v70
    v_exp_f32 v71, v71
    v_exp_f32 v72, v72
    s_waitcnt lgkmcnt(6)
    v_mfma_f32_32x32x16_bf16 v[80:95], v[40:43], v[120:123], v[80:95]
    ds_read_b128 v[40:43], v14 offset:32768
    v_exp_f32 v73, v73
    v_exp_f32 v74, v74
    v_exp_f32 v75, v75
    v_mfma_f32_32x32x16_bf16 v[80:95], v[44:47], v[124:127], v[80:95]
    ds_read_b128 v[44:47], v15 offset:32768
    v_mov_b32 v3, 4
    ds_write_b32 v5, v3
    v_exp_f32 v76, v76
    v_exp_f32 v77, v77
    v_exp_f32 v78, v78
    v_exp_f32 v79, v79
    v_cvt_pk_bf16_f32 v144, v64, v65
    v_cvt_pk_bf16_f32 v145, v66, v67
    v_cvt_pk_bf16_f32 v146, v68, v69
    v_cvt_pk_bf16_f32 v147, v70, v71
    v_cvt_pk_bf16_f32 v148, v72, v73
    v_cvt_pk_bf16_f32 v149, v74, v75
    v_cvt_pk_bf16_f32 v150, v76, v77
    v_cvt_pk_bf16_f32 v151, v78, v79
    s_waitcnt lgkmcnt(7)
    v_mfma_f32_32x32x16_bf16 v[64:79], v[16:19], v[96:99], v[48:63]
    ds_read_b128 v[16:19], v8 offset:40960
    v_max3_f32 v0, v80, v81, v82
    v_max3_f32 v0, v0, v83, v84
    v_max3_f32 v0, v0, v85, v86
    v_mfma_f32_32x32x16_bf16 v[64:79], v[20:23], v[100:103], v[64:79]
    ds_read_b128 v[20:23], v9 offset:40960
    ds_read_b32 v6, v4
    v_max3_f32 v0, v0, v87, v88
    v_max3_f32 v0, v0, v89, v90
    v_max3_f32 v0, v0, v91, v92
    s_waitcnt lgkmcnt(8)
    v_mfma_f32_32x32x16_bf16 v[64:79], v[24:27], v[104:107], v[64:79]
    ds_read_b128 v[24:27], v10 offset:40960
    v_max3_f32 v0, v0, v93, v94
    v_max_f32 v0, v0, v95
    v_cmp_lt_f32 vcc, s68, v0
    v_mfma_f32_32x32x16_bf16 v[64:79], v[28:31], v[108:111], v[64:79]
    ds_read_b128 v[28:31], v11 offset:40960
    s_cbranch_vccnz L_rare_3
L_back_3:
    v_exp_f32 v80, v80
    v_exp_f32 v81, v81
    v_exp_f32 v82, v82
    s_waitcnt lgkmcnt(8)
    v_mfma_f32_32x32x16_bf16 v[64:79], v[32:35], v[112:115], v[64:79]
    ds_read_b128 v[32:35], v12 offset:40960
    v_exp_f32 v83, v83
    v_exp_f32 v84, v84
    v_exp_f32 v85, v85
    v_mfma_f32_32x32x16_bf16 v[64:79], v[36:39], v[116:119], v[64:79]
    ds_read_b128 v[36:39], v13 offset:40960
    v_exp_f32 v86, v86
    v_exp_f32 v87, v87
    v_exp_f32 v88, v88
    s_waitcnt lgkmcnt(8)
    v_mfma_f32_32x32x16_bf16 v[64:79], v[40:43], v[120:123], v[64:79]
    ds_read_b128 v[40:43], v14 offset:40960
    v_exp_f32 v89, v89
    v_exp_f32 v90, v90
    v_exp_f32 v91, v91
    v_mfma_f32_32x32x16_bf16 v[64:79], v[44:47], v[124:127], v[64:79]
    ds_read_b128 v[44:47], v15 offset:40960
    v_exp_f32 v92, v92
    v_exp_f32 v93, v93
    v_exp_f32 v94, v94
    v_exp_f32 v95, v95
    v_cvt_pk_bf16_f32 v152, v80, v81
    v_cvt_pk_bf16_f32 v153, v82, v83
    v_cvt_pk_bf16_f32 v154, v84, v85
    v_cvt_pk_bf16_f32 v155, v86, v87
    v_cvt_pk_bf16_f32 v156, v88, v89
    v_cvt_pk_bf16_f32 v157, v90, v91
    v_cvt_pk_bf16_f32 v158, v92, v93
    v_cvt_pk_bf16_f32 v159, v94, v95
    s_waitcnt lgkmcnt(6)
    v_cmp_gt_u32 vcc, 4, v6
    s_cbranch_vccnz L_sp_k3
L_ok_k3:
    v_mfma_f32_32x32x16_bf16 v[80:95], v[16:19], v[96:99], v[48:63]
    ds_read_b128 v[16:19], v8 offset:49152
    v_max3_f32 v0, v64, v65, v66
    v_max3_f32 v0, v0, v67, v68
    v_max3_f32 v0, v0, v69, v70
    v_mfma_f32_32x32x16_bf16 v[80:95], v[20:23], v[100:103], v[80:95]
    ds_read_b128 v[20:23], v9 offset:49152
    v_max3_f32 v0, v0, v71, v72
    v_max3_f32 v0, v0, v73, v74
    v_max3_f32 v0, v0, v75, v76
    s_waitcnt lgkmcnt(6)
    v_mfma_f32_32x32x16_bf16 v[80:95], v[24:27], v[104:107], v[80:95]
    ds_read_b128 v[24:27], v10 offset:49152
    v_max3_f32 v0, v0, v77, v78
    v_max_f32 v0, v0, v79
    v_cmp_lt_f32 vcc, s68, v0
    v_mfma_f32_32x32x16_bf16 v[80:95], v[28:31], v[108:111], v[80:95]
    ds_read_b128 v[28:31], v11 offset:49152
    s_cbranch_vccnz L_rare_4
L_back_4:
    v_exp_f32 v64, v64
    v_exp_f32 v65, v65
    v_exp_f32 v66, v66
    s_waitcnt lgkmcnt(6)
    v_mfma_f32_32x32x16_bf16 v[80:95], v[32:35], v[112:115], v[80:95]
    ds_read_b128 v[32:35], v12 offset:49152
    v_exp_f32 v67, v67
    v_exp_f32 v68, v68
    v_exp_f32 v69, v69
    v_mfma_f32_32x32x16_bf16 v[80:95], v[36:39], v[116:119], v[80:95]
    ds_read_b128 v[36:39], v13 offset:49152
    v_exp_f32 v70, v70
    v_exp_f32 v71, v71
    v_exp_f32 v72, v72
    s_waitcnt lgkmcnt(6)
    v_mfma_f32_32x32x16_bf16 v[80:95], v[40:43], v[120:123], v[80:95]
    ds_read_b128 v[40:43], v14 offset:49152
    v_exp_f32 v73, v73
    v_exp_f32 v74, v74
    v_exp_f32 v75, v75
    v_mfma_f32_32x32x16_bf16 v[80:95], v[44:47], v[124:127], v[80:95]
    ds_read_b128 v[44:47], v15 offset:49152
    v_mov_b32 v3, 5
    ds_write_b32 v5, v3
    v_exp_f32 v76, v76
    v_exp_f32 v77, v77
    v_exp_f32 v78, v78
    v_exp_f32 v79, v79
    v_cvt_pk_bf16_f32 v160, v64, v65
    v_cvt_pk_bf16_f32 v161, v66, v67
    v_cvt_pk_bf16_f32 v162, v68, v69
    v_cvt_pk_bf16_f32 v163, v70, v71
    v_cvt_pk_bf16_f32 v164, v72, v73
    v_cvt_pk_bf16_f32 v165, v74, v75
    v_cvt_pk_bf16_f32 v166, v76, v77
    v_cvt_pk_bf16_f32 v167, v78, v79
    s_waitcnt lgkmcnt(7)
    v_mfma_f32_32x32x16_bf16 v[64:79], v[16:19], v[96:99], v[48:63]
    ds_read_b128 v[16:19], v8 offset:57344
    v_max3_f32 v0, v80, v81, v82
    v_max3_f32 v0, v0, v83, v84
    v_max3_f32 v0, v0, v85, v86
    v_mfma_f32_32x32x16_bf16 v[64:79], v[20:23], v[100:103], v[64:79]
    ds_read_b128 v[20:23], v9 offset:57344
    ds_read_b32 v6, v4
    v_max3_f32 v0, v0, v87, v88
    v_max3_f32 v0, v0, v89, v90
    v_max3_f32 v0, v0, v91, v92
    s_waitcnt lgkmcnt(8)
    v_mfma_f32_32x32x16_bf16 v[64:79], v[24:27], v[104:107], v[64:79]
    ds_read_b128 v[24:27], v10 offset:57344
    v_max3_f32 v0, v0, v93, v94
    v_max_f32 v0, v0, v95
    v_cmp_lt_f32 vcc, s68, v0
    v_mfma_f32_32x32x16_bf16 v[64:79], v[28:31], v[108:111], v[64:79]
    ds_read_b128 v[28:31], v11 offset:57344
    s_cbranch_vccnz L_rare_5
L_back_5:
    v_exp_f32 v80, v80
    v_exp_f32 v81, v81
    v_exp_f32 v82, v82
    s_waitcnt lgkmcnt(8)
    v_mfma_f32_32x32x16_bf16 v[64:79], v[32:35], v[112:115], v[64:79]
    ds_read_b128 v[32:35], v12 offset:57344
    v_exp_f32 v83, v83
    v_exp_f32 v84, v84
    v_exp_f32 v85, v85
    v_mfma_f32_32x32x16_bf16 v[64:79], v[36:39], v[116:119], v[64:79]
    ds_read_b128 v[36:39], v13 offset:57344
    v_exp_f32 v86, v86
    v_exp_f32 v87, v87
    v_exp_f32 v88, v88
    s_waitcnt lgkmcnt(8)
    v_mfma_f32_32x32x16_bf16 v[64:79], v[40:43], v[120:123], v[64:79]
    ds_read_b128 v[40:43], v14 offset:57344
    v_exp_f32 v89, v89
    v_exp_f32 v90, v90
    v_exp_f32 v91, v91
    v_mfma_f32_32x32x16_bf16 v[64:79], v[44:47], v[124:127], v[64:79]
    ds_read_b128 v[44:47], v15 offset:57344
    v_exp_f32 v92, v92
    v_exp_f32 v93, v93
    v_exp_f32 v94, v94
    v_exp_f32 v95, v95
    v_cvt_pk_bf16_f32 v168, v80, v81
    v_cvt_pk_bf16_f32 v169, v82, v83
    v_cvt_pk_bf16_f32 v170, v84, v85
    v_cvt_pk_bf16_f32 v171, v86, v87
    v_cvt_pk_bf16_f32 v172, v88, v89
    v_cvt_pk_bf16_f32 v173, v90, v91
    v_cvt_pk_bf16_f32 v174, v92, v93
    v_cvt_pk_bf16_f32 v175, v94, v95
    s_waitcnt lgkmcnt(6)
    v_cmp_gt_u32 vcc, 5, v6
    s_cbranch_vccnz L_sp_k4
L_ok_k4:
    v_mfma_f32_32x32x16_bf16 v[80:95], v[16:19], v[96:99], v[48:63]
    v_add_u32 v8, 0x10000, v8
    ds_read_b128 v[16:19], v8 offset:0
    v_max3_f32 v0, v64, v65, v66
    v_max3_f32 v0, v0, v67, v68
    v_max3_f32 v0, v0, v69, v70
    v_mfma_f32_32x32x16_bf16 v[80:95], v[20:23], v[100:103], v[80:95]
    v_add_u32 v9, 0x10000, v9
    ds_read_b128 v[20:23], v9 offset:0
    v_max3_f32 v0, v0, v71, v72
    v_max3_f32 v0, v0, v73, v74
    v_max3_f32 v0, v0, v75, v76
    s_waitcnt lgkmcnt(6)
    v_mfma_f32_32x32x16_bf16 v[80:95], v[24:27], v[104:107], v[80:95]
    v_add_u32 v10, 0x10000, v10
    ds_read_b128 v[24:27], v10 offset:0
    v_max3_f32 v0, v0, v77, v78
    v_max_f32 v0, v0, v79
    v_cmp_lt_f32 vcc, s68, v0
    v_mfma_f32_32x32x16_bf16 v[80:95], v[28:31], v[108:111], v[80:95]
    v_add_u32 v11, 0x10000, v11
    ds_read_b128 v[28:31], v11 offset:0
    s_cbranch_vccnz L_rare_6
L_back_6:
    v_exp_f32 v64, v64
    v_exp_f32 v65, v65
    v_exp_f32 v66, v66
    s_waitcnt lgkmcnt(6)
    v_mfma_f32_32x32x16_bf16 v[80:95], v[32:35], v[112:115], v[80:95]
    v_add_u32 v12, 0x10000, v12
    ds_read_b128 v[32:35], v12 offset:0
    v_exp_f32 v67, v67
    v_exp_f32 v68, v68
    v_exp_f32 v69, v69
    v_mfma_f32_32x32x16_bf16 v[80:95], v[36:39], v[116:119], v[80:95]
    v_add_u32 v13, 0x10000, v13
    ds_read_b128 v[36:39], v13 offset:0
    v_exp_f32 v70, v70
    v_exp_f32 v71, v71
    v_exp_f32 v72, v72
    s_waitcnt lgkmcnt(6)
    v_mfma_f32_32x32x16_bf16 v[80:95], v[40:43], v[120:123], v[80:95]
    v_add_u32 v14, 0x10000, v14
    ds_read_b128 v[40:43], v14 offset:0
    v_exp_f32 v73, v73
    v_exp_f32 v74, v74
    v_exp_f32 v75, v75
    v_mfma_f32_32x32x16_bf16 v[80:95], v[44:47], v[124:127], v[80:95]
    v_add_u32 v15, 0x10000, v15
    ds_read_b128 v[44:47], v15 offset:0
    v_mov_b32 v3, 6
    ds_write_b32 v5, v3
    v_exp_f32 v76, v76
    v_exp_f32 v77, v77
    v_exp_f32 v78, v78
    v_exp_f32 v79, v79
    v_cvt_pk_bf16_f32 v176, v64, v65
    v_cvt_pk_bf16_f32 v177, v66, v67
    v_cvt_pk_bf16_f32 v178, v68, v69
    v_cvt_pk_bf16_f32 v179, v70, v71
    v_cvt_pk_bf16_f32 v180, v72, v73
    v_cvt_pk_bf16_f32 v181, v74, v75
    v_cvt_pk_bf16_f32 v182, v76, v77
    v_cvt_pk_bf16_f32 v183, v78, v79
    s_waitcnt lgkmcnt(7)
    v_mfma_f32_32x32x16_bf16 v[64:79], v[16:19], v[96:99], v[48:63]
    ds_read_b128 v[16:19], v8 offset:8192
    v_max3_f32 v0, v80, v81, v82
    v_max3_f32 v0, v0, v83, v84
    v_max3_f32 v0, v0, v85, v86
    v_mfma_f32_32x32x16_bf16 v[64:79], v[20:23], v[100:103], v[64:79]
    ds_read_b128 v[20:23], v9 offset:8192
    ds_read_b32 v6, v4
    v_max3_f32 v0, v0, v87, v88
    v_max3_f32 v0, v0, v89, v90
    v_max3_f32 v0, v0, v91, v92
    s_waitcnt lgkmcnt(8)
    v_mfma_f32_32x32x16_bf16 v[64:79], v[24:27], v[104:107], v[64:79]
    ds_read_b128 v[24:27], v10 offset:8192
    v_max3_f32 v0, v0, v93, v94
    v_max_f32 v0, v0, v95
    v_cmp_lt_f32 vcc, s68, v0
    v_mfma_f32_32x32x16_bf16 v[64:79], v[28:31], v[108:111], v[64:79]
    ds_read_b128 v[28:31], v11 offset:8192
    s_cbranch_vccnz L_rare_7
L_back_7:
    v_exp_f32 v80, v80
    v_exp_f32 v81, v81
    v_exp_f32 v82, v82
    s_waitcnt lgkmcnt(8)
    v_mfma_f32_32x32x16_bf16 v[64:79], v[32:35], v[112:115], v[64:79]
    ds_read_b128 v[32:35], v12 offset:8192
    v_exp_f32 v83, v83
    v_exp_f32 v84, v84
    v_exp_f32 v85, v85
    v_mfma_f32_32x32x16_bf16 v[64:79], v[36:39], v[116:119], v[64:79]
    ds_read_b128 v[36:39], v13 offset:8192
    v_exp_f32 v86, v86
    v_exp_f32 v87, v87
    v_exp_f32 v88, v88
    s_waitcnt lgkmcnt(8)
    v_mfma_f32_32x32x16_bf16 v[64:79], v[40:43], v[120:123], v[64:79]
    ds_read_b128 v[40:43], v14 offset:8192
    v_exp_f32 v89, v89
    v_exp_f32 v90, v90
    v_exp_f32 v91, v91
    v_mfma_f32_32x32x16_bf16 v[64:79], v[44:47], v[124:127], v[64:79]
    ds_read_b128 v[44:47], v15 offset:8192
    v_exp_f32 v92, v92
    v_exp_f32 v93, v93
    v_exp_f32 v94, v94
    v_exp_f32 v95, v95
    v_cvt_pk_bf16_f32 v184, v80, v81
    v_cvt_pk_bf16_f32 v185, v82, v83
    v_cvt_pk_bf16_f32 v186, v84, v85
    v_cvt_pk_bf16_f32 v187, v86, v87
    v_cvt_pk_bf16_f32 v188, v88, v89
    v_cvt_pk_bf16_f32 v189, v90, v91
    v_cvt_pk_bf16_f32 v190, v92, v93
    v_cvt_pk_bf16_f32 v191, v94, v95
    s_waitcnt lgkmcnt(6)
    v_cmp_gt_u32 vcc, 6, v6
    s_cbranch_vccnz L_sp_k5
L_ok_k5:
    v_mfma_f32_32x32x16_bf16 v[80:95], v[16:19], v[96:99], v[48:63]
    ds_read_b128 v[16:19], v8 offset:16384
    v_max3_f32 v0, v64, v65, v66
    v_max3_f32 v0, v0, v67, v68
    v_max3_f32 v0, v0, v69, v70
    v_mfma_f32_32x32x16_bf16 v[80:95], v[20:23], v[100:103], v[80:95]
    ds_read_b128 v[20:23], v9 offset:16384
    v_max3_f32 v0, v0, v71, v72
    v_max3_f32 v0, v0, v73, v74
    v_max3_f32 v0, v0, v75, v76
    s_waitcnt lgkmcnt(6)
    v_mfma_f32_32x32x16_bf16 v[80:95], v[24:27], v[104:107], v[80:95]
    ds_read_b128 v[24:27], v10 offset:16384
    v_max3_f32 v0, v0, v77, v78
    v_max_f32 v0, v0, v79
    v_cmp_lt_f32 vcc, s68, v0
    v_mfma_f32_32x32x16_bf16 v[80:95], v[28:31], v[108:111], v[80:95]
    ds_read_b128 v[28:31], v11 offset:16384
    s_cbranch_vccnz L_rare_8
L_back_8:
    v_exp_f32 v64, v64
    v_exp_f32 v65, v65
    v_exp_f32 v66, v66
    s_waitcnt lgkmcnt(6)
    v_mfma_f32_32x32x16_bf16 v[80:95], v[32:35], v[112:115], v[80:95]
    ds_read_b128 v[32:35], v12 offset:16384
    v_exp_f32 v67, v67
    v_exp_f32 v68, v68
    v_exp_f32 v69, v69
    v_mfma_f32_32x32x16_bf16 v[80:95], v[36:39], v[116:119], v[80:95]
    ds_read_b128 v[36:39], v13 offset:16384
    v_exp_f32 v70, v70
    v_exp_f32 v71, v71
    v_exp_f32 v72, v72
    s_waitcnt lgkmcnt(6)
    v_mfma_f32_32x32x16_bf16 v[80:95], v[40:43], v[120:123], v[80:95]
    ds_read_b128 v[40:43], v14 offset:16384
    v_exp_f32 v73, v73
    v_exp_f32 v74, v74
    v_exp_f32 v75, v75
    v_mfma_f32_32x32x16_bf16 v[80:95], v[44:47], v[124:127], v[80:95]
    ds_read_b128 v[44:47], v15 offset:16384
    v_mov_b32 v3, 7
    ds_write_b32 v5, v3
    v_exp_f32 v76, v76
    v_exp_f32 v77, v77
    v_exp_f32 v78, v78
    v_exp_f32 v79, v79
    v_cvt_pk_bf16_f32 v192, v64, v65
    v_cvt_pk_bf16_f32 v193, v66, v67
    v_cvt_pk_bf16_f32 v194, v68, v69
    v_cvt_pk_bf16_f32 v195, v70, v71
    v_cvt_pk_bf16_f32 v196, v72, v73
    v_cvt_pk_bf16_f32 v197, v74, v75
    v_cvt_pk_bf16_f32 v198, v76, v77
    v_cvt_pk_bf16_f32 v199, v78, v79
    s_waitcnt lgkmcnt(7)
    v_mfma_f32_32x32x16_bf16 v[64:79], v[16:19], v[96:99], v[48:63]
    ds_read_b128 v[16:19], v8 offset:24576
    v_max3_f32 v0, v80, v81, v82
    v_max3_f32 v0, v0, v83, v84
    v_max3_f32 v0, v0, v85, v86
    v_mfma_f32_32x32x16_bf16 v[64:79], v[20:23], v[100:103], v[64:79]
    ds_read_b128 v[20:23], v9 offset:24576
    ds_read_b32 v6, v4
    v_max3_f32 v0, v0, v87, v88
    v_max3_f32 v0, v0, v89, v90
    v_max3_f32 v0, v0, v91, v92
    s_waitcnt lgkmcnt(8)
    v_mfma_f32_32x32x16_bf16 v[64:79], v[24:27], v[104:107], v[64:79]
    ds_read_b128 v[24:27], v10 offset:24576
    v_max3_f32 v0, v0, v93, v94
    v_max_f32 v0, v0, v95
    v_cmp_lt_f32 vcc, s68, v0
    v_mfma_f32_32x32x16_bf16 v[64:79], v[28:31], v[108:111], v[64:79]
    ds_read_b128 v[28:31], v11 offset:24576
    s_cbranch_vccnz L_rare_9
L_back_9:
    v_exp_f32 v80, v80
    v_exp_f32 v81, v81
    v_exp_f32 v82, v82
    s_waitcnt lgkmcnt(8)
    v_mfma_f32_32x32x16_bf16 v[64:79], v[32:35], v[112:115], v[64:79]
    ds_read_b128 v[32:35], v12 offset:24576
    v_exp_f32 v83, v83
    v_exp_f32 v84, v84
    v_exp_f32 v85, v85
    v_mfma_f32_32x32x16_bf16 v[64:79], v[36:39], v[116:119], v[64:79]
    ds_read_b128 v[36:39], v13 offset:24576
    v_exp_f32 v86, v86
    v_exp_f32 v87, v87
    v_exp_f32 v88, v88
    s_waitcnt lgkmcnt(8)
    v_mfma_f32_32x32x16_bf16 v[64:79], v[40:43], v[120:123], v[64:79]
    ds_read_b128 v[40:43], v14 offset:24576
    v_exp_f32 v89, v89
    v_exp_f32 v90, v90
    v_exp_f32 v91, v91
    v_mfma_f32_32x32x16_bf16 v[64:79], v[44:47], v[124:127], v[64:79]
    ds_read_b128 v[44:47], v15 offset:24576
    v_exp_f32 v92, v92
    v_exp_f32 v93, v93
    v_exp_f32 v94, v94
    v_exp_f32 v95, v95
    v_cvt_pk_bf16_f32 v200, v80, v81
    v_cvt_pk_bf16_f32 v201, v82, v83
    v_cvt_pk_bf16_f32 v202, v84, v85
    v_cvt_pk_bf16_f32 v203, v86, v87
    v_cvt_pk_bf16_f32 v204, v88, v89
    v_cvt_pk_bf16_f32 v205, v90, v91
    v_cvt_pk_bf16_f32 v206, v92, v93
    v_cvt_pk_bf16_f32 v207, v94, v95
    s_waitcnt lgkmcnt(6)
    v_cmp_gt_u32 vcc, 7, v6
    s_cbranch_vccnz L_sp_k6
L_ok_k6:
    v_mfma_f32_32x32x16_bf16 v[80:95], v[16:19], v[96:99], v[48:63]
    ds_read_b128 v[16:19], v8 offset:32768
    v_max3_f32 v0, v64, v65, v66
    v_max3_f32 v0, v0, v67, v68
    v_max3_f32 v0, v0, v69, v70
    v_mfma_f32_32x32x16_bf16 v[80:95], v[20:23], v[100:103], v[80:95]
    ds_read_b128 v[20:23], v9 offset:32768
    v_max3_f32 v0, v0, v71, v72
    v_max3_f32 v0, v0, v73, v74
    v_max3_f32 v0, v0, v75, v76
    s_waitcnt lgkmcnt(6)
    v_mfma_f32_32x32x16_bf16 v[80:95], v[24:27], v[104:107], v[80:95]
    ds_read_b128 v[24:27], v10 offset:32768
    v_max3_f32 v0, v0, v77, v78
    v_max_f32 v0, v0, v79
    v_cmp_lt_f32 vcc, s68, v0
    v_mfma_f32_32x32x16_bf16 v[80:95], v[28:31], v[108:111], v[80:95]
    ds_read_b128 v[28:31], v11 offset:32768
    s_cbranch_vccnz L_rare_10
L_back_10:
    v_exp_f32 v64, v64
    v_exp_f32 v65, v65
    v_exp_f32 v66, v66
    s_waitcnt lgkmcnt(6)
    v_mfma_f32_32x32x16_bf16 v[80:95], v[32:35], v[112:115], v[80:95]
    ds_read_b128 v[32:35], v12 offset:32768
    v_exp_f32 v67, v67
    v_exp_f32 v68, v68
    v_exp_f32 v69, v69
    v_mfma_f32_32x32x16_bf16 v[80:95], v[36:39], v[116:119], v[80:95]
    ds_read_b128 v[36:39], v13 offset:32768
    v_exp_f32 v70, v70
    v_exp_f32 v71, v71
    v_exp_f32 v72, v72
    s_waitcnt lgkmcnt(6)
    v_mfma_f32_32x32x16_bf16 v[80:95], v[40:43], v[120:123], v[80:95]
    ds_read_b128 v[40:43], v14 offset:32768
    v_exp_f32 v73, v73
    v_exp_f32 v74, v74
    v_exp_f32 v75, v75
    v_mfma_f32_32x32x16_bf16 v[80:95], v[44:47], v[124:127], v[80:95]
    ds_read_b128 v[44:47], v15 offset:32768
    v_mov_b32 v3, 8
    ds_write_b32 v5, v3
    v_exp_f32 v76, v76
    v_exp_f32 v77, v77
    v_exp_f32 v78, v78
    v_exp_f32 v79, v79
    v_cvt_pk_bf16_f32 v208, v64, v65
    v_cvt_pk_bf16_f32 v209, v66, v67
    v_cvt_pk_bf16_f32 v210, v68, v69
    v_cvt_pk_bf16_f32 v211, v70, v71
    v_cvt_pk_bf16_f32 v212, v72, v73
    v_cvt_pk_bf16_f32 v213, v74, v75
    v_cvt_pk_bf16_f32 v214, v76, v77
    v_cvt_pk_bf16_f32 v215, v78, v79
    s_waitcnt lgkmcnt(7)
    v_mfma_f32_32x32x16_bf16 v[64:79], v[16:19], v[96:99], v[48:63]
    ds_read_b128 v[16:19], v8 offset:40960
    v_max3_f32 v0, v80, v81, v82
    v_max3_f32 v0, v0, v83, v84
    v_max3_f32 v0, v0, v85, v86
    v_mfma_f32_32x32x16_bf16 v[64:79], v[20:23], v[100:103], v[64:79]
    ds_read_b128 v[20:23], v9 offset:40960
    ds_read_b32 v6, v4
    v_max3_f32 v0, v0, v87, v88
    v_max3_f32 v0, v0, v89, v90
    v_max3_f32 v0, v0, v91, v92
    s_waitcnt lgkmcnt(8)
    v_mfma_f32_32x32x16_bf16 v[64:79], v[24:27], v[104:107], v[64:79]
    ds_read_b128 v[24:27], v10 offset:40960
    v_max3_f32 v0, v0, v93, v94
    v_max_f32 v0, v0, v95
    v_cmp_lt_f32 vcc, s68, v0
    v_mfma_f32_32x32x16_bf16 v[64:79], v[28:31], v[108:111], v[64:79]
    ds_read_b128 v[28:31], v11 offset:40960
    s_cbranch_vccnz L_rare_11
L_back_11:
    v_exp_f32 v80, v80
    v_exp_f32 v81, v81
    v_exp_f32 v82, v82
    s_waitcnt lgkmcnt(8)
    v_mfma_f32_32x32x16_bf16 v[64:79], v[32:35], v[112:115], v[64:79]
    ds_read_b128 v[32:35], v12 offset:40960
    v_exp_f32 v83, v83
    v_exp_f32 v84, v84
    v_exp_f32 v85, v85
    v_mfma_f32_32x32x16_bf16 v[64:79], v[36:39], v[116:119], v[64:79]
    ds_read_b128 v[36:39], v13 offset:40960
    v_exp_f32 v86, v86
    v_exp_f32 v87, v87
    v_exp_f32 v88, v88
    s_waitcnt lgkmcnt(8)
    v_mfma_f32_32x32x16_bf16 v[64:79], v[40:43], v[120:123], v[64:79]
    ds_read_b128 v[40:43], v14 offset:40960
    v_exp_f32 v89, v89
    v_exp_f32 v90, v90
    v_exp_f32 v91, v91
    v_mfma_f32_32x32x16_bf16 v[64:79], v[44:47], v[124:127], v[64:79]
    ds_read_b128 v[44:47], v15 offset:40960
    v_exp_f32 v92, v92
    v_exp_f32 v93, v93
    v_exp_f32 v94, v94
    v_exp_f32 v95, v95
    v_cvt_pk_bf16_f32 v216, v80, v81
    v_cvt_pk_bf16_f32 v217, v82, v83
    v_cvt_pk_bf16_f32 v218, v84, v85
    v_cvt_pk_bf16_f32 v219, v86, v87
    v_cvt_pk_bf16_f32 v220, v88, v89
    v_cvt_pk_bf16_f32 v221, v90, v91
    v_cvt_pk_bf16_f32 v222, v92, v93
    v_cvt_pk_bf16_f32 v223, v94, v95
    s_waitcnt lgkmcnt(6)
    v_cmp_gt_u32 vcc, 8, v6
    s_cbranch_vccnz L_sp_k7
L_ok_k7:
    v_mfma_f32_32x32x16_bf16 v[80:95], v[16:19], v[96:99], v[48:63]
    v_add_u32 v8, 0x10000, v8
    ds_read_b128 v[16:19], v8 offset:0
    v_max3_f32 v0, v64, v65, v66
    v_max3_f32 v0, v0, v67, v68
    v_max3_f32 v0, v0, v69, v70
    v_mfma_f32_32x32x16_bf16 v[80:95], v[20:23], v[100:103], v[80:95]
    v_add_u32 v9, 0x10000, v9
    ds_read_b128 v[20:23], v9 offset:0
    v_max3_f32 v0, v0, v71, v72
    v_max3_f32 v0, v0, v73, v74
    v_max3_f32 v0, v0, v75, v76
    s_waitcnt lgkmcnt(6)
    v_mfma_f32_32x32x16_bf16 v[80:95], v[24:27], v[104:107], v[80:95]
    v_add_u32 v10, 0x10000, v10
    ds_read_b128 v[24:27], v10 offset:0
    v_max3_f32 v0, v0, v77, v78
    v_max_f32 v0, v0, v79
    v_cmp_lt_f32 vcc, s68, v0
    v_mfma_f32_32x32x16_bf16 v[80:95], v[28:31], v[108:111], v[80:95]
    v_add_u32 v11, 0x10000, v11
    ds_read_b128 v[28:31], v11 offset:0
    s_cbranch_vccnz L_rare_12
L_back_12:
    v_exp_f32 v64, v64
    v_exp_f32 v65, v65
    v_exp_f32 v66, v66
    s_waitcnt lgkmcnt(6)
    v_mfma_f32_32x32x16_bf16 v[80:95], v[32:35], v[112:115], v[80:95]
    v_add_u32 v12, 0x10000, v12
    ds_read_b128 v[32:35], v12 offset:0
    v_exp_f32 v67, v67
    v_exp_f32 v68, v68
    v_exp_f32 v69, v69
    v_mfma_f32_32x32x16_bf16 v[80:95], v[36:39], v[116:119], v[80:95]
    v_add_u32 v13, 0x10000, v13
    ds_read_b128 v[36:39], v13 offset:0
    v_exp_f32 v70, v70
    v_exp_f32 v71, v71
    v_exp_f32 v72, v72
    s_waitcnt lgkmcnt(6)
    v_mfma_f32_32x32x16_bf16 v[80:95], v[40:43], v[120:123], v[80:95]
    v_add_u32 v14, 0x10000, v14
    ds_read_b128 v[40:43], v14 offset:0
    v_exp_f32 v73, v73
    v_exp_f32 v74, v74
    v_exp_f32 v75, v75
    v_mfma_f32_32x32x16_bf16 v[80:95], v[44:47], v[124:127], v[80:95]
    v_add_u32 v15, 0x10000, v15
    ds_read_b128 v[44:47], v15 offset:0
    v_mov_b32 v3, 9
    ds_write_b32 v5, v3
    v_exp_f32 v76, v76
    v_exp_f32 v77, v77
    v_exp_f32 v78, v78
    v_exp_f32 v79, v79
    v_cvt_pk_bf16_f32 v224, v64, v65
    v_cvt_pk_bf16_f32 v225, v66, v67
    v_cvt_pk_bf16_f32 v226, v68, v69
    v_cvt_pk_bf16_f32 v227, v70, v71
    v_cvt_pk_bf16_f32 v228, v72, v73
    v_cvt_pk_bf16_f32 v229, v74, v75
    v_cvt_pk_bf16_f32 v230, v76, v77
    v_cvt_pk_bf16_f32 v231, v78, v79
    s_waitcnt lgkmcnt(7)
    v_mfma_f32_32x32x16_bf16 v[64:79], v[16:19], v[96:99], v[48:63]
    ds_read_b128 v[16:19], v8 offset:8192
    v_max3_f32 v0, v80, v81, v82
    v_max3_f32 v0, v0, v83, v84
    v_max3_f32 v0, v0, v85, v86
    v_mfma_f32_32x32x16_bf16 v[64:79], v[20:23], v[100:103], v[64:79]
    ds_read_b128 v[20:23], v9 offset:8192
    v_max3_f32 v0, v0, v87, v88
    v_max3_f32 v0, v0, v89, v90
    v_max3_f32 v0, v0, v91, v92
    s_waitcnt lgkmcnt(7)
    v_mfma_f32_32x32x16_bf16 v[64:79], v[24:27], v[104:107], v[64:79]
    ds_read_b128 v[24:27], v10 offset:8192
    v_max3_f32 v0, v0, v93, v94
    v_max_f32 v0, v0, v95
    v_cmp_lt_f32 vcc, s68, v0
    v_mfma_f32_32x32x16_bf16 v[64:79], v[28:31], v[108:111], v[64:79]
    ds_read_b128 v[28:31], v11 offset:8192
    s_cbranch_vccnz L_rare_13
L_back_13:
    v_exp_f32 v80, v80
    v_exp_f32 v81, v81
    v_exp_f32 v82, v82
    s_waitcnt lgkmcnt(7)
    v_mfma_f32_32x32x16_bf16 v[64:79], v[32:35], v[112:115], v[64:79]
    ds_read_b128 v[32:35], v12 offset:8192
    v_exp_f32 v83, v83
    v_exp_f32 v84, v84
    v_exp_f32 v85, v85
    v_mfma_f32_32x32x16_bf16 v[64:79], v[36:39], v[116:119], v[64:79]
    ds_read_b128 v[36:39], v13 offset:8192
    v_exp_f32 v86, v86
    v_exp_f32 v87, v87
    v_exp_f32 v88, v88
    s_waitcnt lgkmcnt(7)
    v_mfma_f32_32x32x16_bf16 v[64:79], v[40:43], v[120:123], v[64:79]
    ds_read_b128 v[40:43], v14 offset:8192
    v_exp_f32 v89, v89
    v_exp_f32 v90, v90
    v_exp_f32 v91, v91
    v_mfma_f32_32x32x16_bf16 v[64:79], v[44:47], v[124:127], v[64:79]
    ds_read_b128 v[44:47], v15 offset:8192
    v_exp_f32 v92, v92
    v_exp_f32 v93, v93
    v_exp_f32 v94, v94
    v_exp_f32 v95, v95
    v_cvt_pk_bf16_f32 v232, v80, v81
    v_cvt_pk_bf16_f32 v233, v82, v83
    v_cvt_pk_bf16_f32 v234, v84, v85
    v_cvt_pk_bf16_f32 v235, v86, v87
    v_cvt_pk_bf16_f32 v236, v88, v89
    v_cvt_pk_bf16_f32 v237, v90, v91
    v_cvt_pk_bf16_f32 v238, v92, v93
    v_cvt_pk_bf16_f32 v239, v94, v95
    s_waitcnt lgkmcnt(6)
    v_mfma_f32_32x32x16_bf16 v[80:95], v[16:19], v[96:99], v[48:63]
    v_max3_f32 v0, v64, v65, v66
    v_max3_f32 v0, v0, v67, v68
    v_max3_f32 v0, v0, v69, v70
    v_mfma_f32_32x32x16_bf16 v[80:95], v[20:23], v[100:103], v[80:95]
    v_max3_f32 v0, v0, v71, v72
    v_max3_f32 v0, v0, v73, v74
    v_max3_f32 v0, v0, v75, v76
    s_waitcnt lgkmcnt(4)
    v_mfma_f32_32x32x16_bf16 v[80:95], v[24:27], v[104:107], v[80:95]
    v_max3_f32 v0, v0, v77, v78
    v_max_f32 v0, v0, v79
    v_cmp_lt_f32 vcc, s68, v0
    v_mfma_f32_32x32x16_bf16 v[80:95], v[28:31], v[108:111], v[80:95]
    s_cbranch_vccnz L_rare_14
L_back_14:
    v_exp_f32 v64, v64
    v_exp_f32 v65, v65
    v_exp_f32 v66, v66
    s_waitcnt lgkmcnt(2)
    v_mfma_f32_32x32x16_bf16 v[80:95], v[32:35], v[112:115], v[80:95]
    v_exp_f32 v67, v67
    v_exp_f32 v68, v68
    v_exp_f32 v69, v69
    v_mfma_f32_32x32x16_bf16 v[80:95], v[36:39], v[116:119], v[80:95]
    v_exp_f32 v70, v70
    v_exp_f32 v71, v71
    v_exp_f32 v72, v72
    s_waitcnt lgkmcnt(0)
    v_mfma_f32_32x32x16_bf16 v[80:95], v[40:43], v[120:123], v[80:95]
    v_exp_f32 v73, v73
    v_exp_f32 v74, v74
    v_exp_f32 v75, v75
    v_mfma_f32_32x32x16_bf16 v[80:95], v[44:47], v[124:127], v[80:95]
    v_mov_b32 v3, 10
    ds_write_b32 v5, v3
    v_exp_f32 v76, v76
    v_exp_f32 v77, v77
    v_exp_f32 v78, v78
    v_exp_f32 v79, v79
    v_cvt_pk_bf16_f32 v240, v64, v65
    v_cvt_pk_bf16_f32 v241, v66, v67
    v_cvt_pk_bf16_f32 v242, v68, v69
    v_cvt_pk_bf16_f32 v243, v70, v71
    v_cvt_pk_bf16_f32 v244, v72, v73
    v_cvt_pk_bf16_f32 v245, v74, v75
    v_cvt_pk_bf16_f32 v246, v76, v77
    v_cvt_pk_bf16_f32 v247, v78, v79
    v_max3_f32 v0, v80, v81, v82
    v_max3_f32 v0, v0, v83, v84
    v_max3_f32 v0, v0, v85, v86
    v_max3_f32 v0, v0, v87, v88
    v_max3_f32 v0, v0, v89, v90
    v_max3_f32 v0, v0, v91, v92
    v_max3_f32 v0, v0, v93, v94
    v_max_f32 v0, v0, v95
    v_cmp_lt_f32 vcc, s68, v0
    s_cbranch_vccnz L_rare_15
L_back_15:
    v_exp_f32 v80, v80
    v_exp_f32 v81, v81
    v_exp_f32 v82, v82
    v_exp_f32 v83, v83
    v_exp_f32 v84, v84
    v_exp_f32 v85, v85
    v_exp_f32 v86, v86
    v_exp_f32 v87, v87
    v_exp_f32 v88, v88
    v_exp_f32 v89, v89
    v_exp_f32 v90, v90
    v_exp_f32 v91, v91
    v_exp_f32 v92, v92
    v_exp_f32 v93, v93
    v_exp_f32 v94, v94
    v_exp_f32 v95, v95
    v_cvt_pk_bf16_f32 v248, v80, v81
    v_cvt_pk_bf16_f32 v249, v82, v83
    v_cvt_pk_bf16_f32 v250, v84, v85
    v_cvt_pk_bf16_f32 v251, v86, v87
    v_cvt_pk_bf16_f32 v252, v88, v89
    v_cvt_pk_bf16_f32 v253, v90, v91
    v_cvt_pk_bf16_f32 v254, v92, v93
    v_cvt_pk_bf16_f32 v255, v94, v95
    ds_read_b32 v6, v4
    v_lshrrev_b32 v1, 5, v7
    v_bfe_u32 v2, v7, 2, 2
    v_lshl_add_u32 v0, v1, 2, v2
    v_lshlrev_b32 v0, 7, v0
    v_bfe_u32 v1, v7, 4, 1
    v_lshl_add_u32 v0, v1, 5, v0
    v_and_b32 v1, 3, v7
    v_lshl_add_u32 v0, v1, 3, v0
    v_add_u32 v0, 147456, v0
    v_bfe_u32 v2, v7, 3, 1
    v_xor_b32 v1, 0, v2
    v_lshl_add_u32 v8, v1, 6, v0
    v_xor_b32 v1, 1, v2
    v_lshl_add_u32 v9, v1, 6, v0
    v_and_b32 v1, 15, v7
    v_bfe_u32 v2, v7, 4, 1
    v_cmp_eq_u32 vcc, v1, v2
    v_mov_b32 v0, 0x3f803f80
    v_mov_b32 v1, 0
    v_cndmask_b32 v48, v1, v0, vcc
    v_mov_b32 v49, v48
    v_mov_b32 v50, v48
    v_mov_b32 v51, v48
    v_add_u32 v10, 16, v5
    s_lshl_b32 s70, s20, 8
    s_add_u32 s70, s70, 131072
    v_and_b32 v11, 31, v7
    v_lshlrev_b32 v11, 10, v11
    v_and_b32 v0, 15, v7
    v_lshl_add_u32 v11, v0, 4, v11
    v_lshrrev_b32 v0, 5, v7
    v_lshl_add_u32 v11, v0, 3, v11
    v_add_u32 v11, s70, v11
    s_waitcnt lgkmcnt(0)
    v_cmp_gt_u32 vcc, 9, v6
    s_nop 1
    s_cbranch_vccnz L_sp_v0
L_ok_v0:
    ds_read_b64_tr_b16 v[16:17], v8 offset:0
    ds_read_b64_tr_b16 v[18:19], v8 offset:1024
    ds_read_b64_tr_b16 v[20:21], v9 offset:0
    ds_read_b64_tr_b16 v[22:23], v9 offset:1024
    ds_read_b64_tr_b16 v[24:25], v8 offset:2048
    ds_read_b64_tr_b16 v[26:27], v8 offset:3072
    ds_read_b64_tr_b16 v[28:29], v9 offset:2048
    ds_read_b64_tr_b16 v[30:31], v9 offset:3072
    ds_read_b64_tr_b16 v[32:33], v8 offset:4096
    ds_read_b64_tr_b16 v[34:35], v8 offset:5120
    ds_read_b64_tr_b16 v[36:37], v9 offset:4096
    ds_read_b64_tr_b16 v[38:39], v9 offset:5120
    s_waitcnt lgkmcnt(10)
    v_mfma_f32_32x32x16_bf16 v[64:79], v[16:19], v[128:131], 0
    ds_read_b64_tr_b16 v[40:41], v8 offset:6144
    ds_read_b64_tr_b16 v[42:43], v8 offset:7168
    v_mfma_f32_16x16x32_bf16 v[12:15], v[48:51], v[128:131], 0
    s_waitcnt lgkmcnt(10)
    v_mfma_f32_32x32x16_bf16 v[80:95], v[20:23], v[128:131], 0
    ds_read_b64_tr_b16 v[44:45], v9 offset:6144
    ds_read_b64_tr_b16 v[46:47], v9 offset:7168
    s_waitcnt lgkmcnt(10)
    v_mfma_f32_32x32x16_bf16 v[64:79], v[24:27], v[132:135], v[64:79]
    ds_read_b64_tr_b16 v[16:17], v8 offset:8192
    ds_read_b64_tr_b16 v[18:19], v8 offset:9216
    ds_read_b32 v6, v4
    v_mfma_f32_16x16x32_bf16 v[12:15], v[48:51], v[132:135], v[12:15]
    s_waitcnt lgkmcnt(11)
    v_mfma_f32_32x32x16_bf16 v[80:95], v[28:31], v[132:135], v[80:95]
    ds_read_b64_tr_b16 v[20:21], v9 offset:8192
    ds_read_b64_tr_b16 v[22:23], v9 offset:9216
    s_waitcnt lgkmcnt(11)
    v_mfma_f32_32x32x16_bf16 v[64:79], v[32:35], v[136:139], v[64:79]
    ds_read_b64_tr_b16 v[24:25], v8 offset:10240
    ds_read_b64_tr_b16 v[26:27], v8 offset:11264
    v_mfma_f32_16x16x32_bf16 v[12:15], v[48:51], v[136:139], v[12:15]
    s_waitcnt lgkmcnt(11)
    v_mfma_f32_32x32x16_bf16 v[80:95], v[36:39], v[136:139], v[80:95]
    ds_read_b64_tr_b16 v[28:29], v9 offset:10240
    ds_read_b64_tr_b16 v[30:31], v9 offset:11264
    s_waitcnt lgkmcnt(11)
    v_mfma_f32_32x32x16_bf16 v[64:79], v[40:43], v[140:143], v[64:79]
    ds_read_b64_tr_b16 v[32:33], v8 offset:12288
    ds_read_b64_tr_b16 v[34:35], v8 offset:13312
    v_mfma_f32_16x16x32_bf16 v[12:15], v[48:51], v[140:143], v[12:15]
    s_waitcnt lgkmcnt(11)
    v_mfma_f32_32x32x16_bf16 v[80:95], v[44:47], v[140:143], v[80:95]
    ds_read_b64_tr_b16 v[36:37], v9 offset:12288
    ds_read_b64_tr_b16 v[38:39], v9 offset:13312
    s_waitcnt lgkmcnt(10)
    v_cmp_gt_u32 vcc, 10, v6
    v_mfma_f32_32x32x16_bf16 v[64:79], v[16:19], v[144:147], v[64:79]
    ds_read_b64_tr_b16 v[40:41], v8 offset:14336
    ds_read_b64_tr_b16 v[42:43], v8 offset:15360
    v_mfma_f32_16x16x32_bf16 v[12:15], v[48:51], v[144:147], v[12:15]
    s_waitcnt lgkmcnt(10)
    v_mfma_f32_32x32x16_bf16 v[80:95], v[20:23], v[144:147], v[80:95]
    ds_read_b64_tr_b16 v[44:45], v9 offset:14336
    ds_read_b64_tr_b16 v[46:47], v9 offset:15360
    s_waitcnt lgkmcnt(10)
    v_mfma_f32_32x32x16_bf16 v[64:79], v[24:27], v[148:151], v[64:79]
    s_cbranch_vccnz L_sp_v1
L_ok_v1:
    v_subrev_u32 v8, 147456, v8
    ds_read_b64_tr_b16 v[16:17], v8 offset:0
    ds_read_b64_tr_b16 v[18:19], v8 offset:1024
    v_mfma_f32_16x16x32_bf16 v[12:15], v[48:51], v[148:151], v[12:15]
    s_waitcnt lgkmcnt(10)
    v_mfma_f32_32x32x16_bf16 v[80:95], v[28:31], v[148:151], v[80:95]
    v_subrev_u32 v9, 147456, v9
    ds_read_b64_tr_b16 v[20:21], v9 offset:0
    ds_read_b64_tr_b16 v[22:23], v9 offset:1024
    s_waitcnt lgkmcnt(10)
    v_mfma_f32_32x32x16_bf16 v[64:79], v[32:35], v[152:155], v[64:79]
    ds_read_b64_tr_b16 v[24:25], v8 offset:2048
    ds_read_b64_tr_b16 v[26:27], v8 offset:3072
    v_mfma_f32_16x16x32_bf16 v[12:15], v[48:51], v[152:155], v[12:15]
    s_waitcnt lgkmcnt(10)
    v_mfma_f32_32x32x16_bf16 v[80:95], v[36:39], v[152:155], v[80:95]
    ds_read_b64_tr_b16 v[28:29], v9 offset:2048
    ds_read_b64_tr_b16 v[30:31], v9 offset:3072
    s_waitcnt lgkmcnt(10)
    v_mfma_f32_32x32x16_bf16 v[64:79], v[40:43], v[156:159], v[64:79]
    ds_read_b64_tr_b16 v[32:33], v8 offset:4096
    ds_read_b64_tr_b16 v[34:35], v8 offset:5120
    v_mfma_f32_16x16x32_bf16 v[12:15], v[48:51], v[156:159], v[12:15]
    s_waitcnt lgkmcnt(10)
    v_mfma_f32_32x32x16_bf16 v[80:95], v[44:47], v[156:159], v[80:95]
    ds_read_b64_tr_b16 v[36:37], v9 offset:4096
    ds_read_b64_tr_b16 v[38:39], v9 offset:5120
    v_mov_b32 v3, 11
    ds_write_b32 v5, v3
    s_waitcnt lgkmcnt(11)
    v_mfma_f32_32x32x16_bf16 v[64:79], v[16:19], v[160:163], v[64:79]
    ds_read_b64_tr_b16 v[40:41], v8 offset:6144
    ds_read_b64_tr_b16 v[42:43], v8 offset:7168
    v_mfma_f32_16x16x32_bf16 v[12:15], v[48:51], v[160:163], v[12:15]
    s_waitcnt lgkmcnt(11)
    v_mfma_f32_32x32x16_bf16 v[80:95], v[20:23], v[160:163], v[80:95]
    ds_read_b64_tr_b16 v[44:45], v9 offset:6144
    ds_read_b64_tr_b16 v[46:47], v9 offset:7168
    s_waitcnt lgkmcnt(11)
    v_mfma_f32_32x32x16_bf16 v[64:79], v[24:27], v[164:167], v[64:79]
    ds_read_b64_tr_b16 v[16:17], v8 offset:8192
    ds_read_b64_tr_b16 v[18:19], v8 offset:9216
    ds_read_b32 v6, v4
    v_mfma_f32_16x16x32_bf16 v[12:15], v[48:51], v[164:167], v[12:15]
    s_waitcnt lgkmcnt(12)
    v_mfma_f32_32x32x16_bf16 v[80:95], v[28:31], v[164:167], v[80:95]
    ds_read_b64_tr_b16 v[20:21], v9 offset:8192
    ds_read_b64_tr_b16 v[22:23], v9 offset:9216
    s_waitcnt lgkmcnt(12)
    v_mfma_f32_32x32x16_bf16 v[64:79], v[32:35], v[168:171], v[64:79]
    ds_read_b64_tr_b16 v[24:25], v8 offset:10240
    ds_read_b64_tr_b16 v[26:27], v8 offset:11264
    v_mfma_f32_16x16x32_bf16 v[12:15], v[48:51], v[168:171], v[12:15]
    s_waitcnt lgkmcnt(12)
    v_mfma_f32_32x32x16_bf16 v[80:95], v[36:39], v[168:171], v[80:95]
    ds_read_b64_tr_b16 v[28:29], v9 offset:10240
    ds_read_b64_tr_b16 v[30:31], v9 offset:11264
    s_waitcnt lgkmcnt(11)
    v_mfma_f32_32x32x16_bf16 v[64:79], v[40:43], v[172:175], v[64:79]
    ds_read_b64_tr_b16 v[32:33], v8 offset:12288
    ds_read_b64_tr_b16 v[34:35], v8 offset:13312
    v_mfma_f32_16x16x32_bf16 v[12:15], v[48:51], v[172:175], v[12:15]
    s_waitcnt lgkmcnt(11)
    v_mfma_f32_32x32x16_bf16 v[80:95], v[44:47], v[172:175], v[80:95]
    ds_read_b64_tr_b16 v[36:37], v9 offset:12288
    ds_read_b64_tr_b16 v[38:39], v9 offset:13312
    s_waitcnt lgkmcnt(10)
    v_cmp_gt_u32 vcc, 11, v6
    v_mfma_f32_32x32x16_bf16 v[64:79], v[16:19], v[176:179], v[64:79]
    ds_read_b64_tr_b16 v[40:41], v8 offset:14336
    ds_read_b64_tr_b16 v[42:43], v8 offset:15360
    v_mfma_f32_16x16x32_bf16 v[12:15], v[48:51], v[176:179], v[12:15]
    s_waitcnt lgkmcnt(10)
    v_mfma_f32_32x32x16_bf16 v[80:95], v[20:23], v[176:179], v[80:95]
    ds_read_b64_tr_b16 v[44:45], v9 offset:14336
    ds_read_b64_tr_b16 v[46:47], v9 offset:15360
    s_waitcnt lgkmcnt(10)
    v_mfma_f32_32x32x16_bf16 v[64:79], v[24:27], v[180:183], v[64:79]
    s_cbranch_vccnz L_sp_v2
L_ok_v2:
    ds_read_b64_tr_b16 v[16:17], v8 offset:16384
    ds_read_b64_tr_b16 v[18:19], v8 offset:17408
    v_mfma_f32_16x16x32_bf16 v[12:15], v[48:51], v[180:183], v[12:15]
    s_waitcnt lgkmcnt(10)
    v_mfma_f32_32x32x16_bf16 v[80:95], v[28:31], v[180:183], v[80:95]
    ds_read_b64_tr_b16 v[20:21], v9 offset:16384
    ds_read_b64_tr_b16 v[22:23], v9 offset:17408
    s_waitcnt lgkmcnt(10)
    v_mfma_f32_32x32x16_bf16 v[64:79], v[32:35], v[184:187], v[64:79]
    ds_read_b64_tr_b16 v[24:25], v8 offset:18432
    ds_read_b64_tr_b16 v[26:27], v8 offset:19456
    v_mfma_f32_16x16x32_bf16 v[12:15], v[48:51], v[184:187], v[12:15]
    s_waitcnt lgkmcnt(10)
    v_mfma_f32_32x32x16_bf16 v[80:95], v[36:39], v[184:187], v[80:95]
    ds_read_b64_tr_b16 v[28:29], v9 offset:18432
    ds_read_b64_tr_b16 v[30:31], v9 offset:19456
    s_waitcnt lgkmcnt(10)
    v_mfma_f32_32x32x16_bf16 v[64:79], v[40:43], v[188:191], v[64:79]
    ds_read_b64_tr_b16 v[32:33], v8 offset:20480
    ds_read_b64_tr_b16 v[34:35], v8 offset:21504
    v_mfma_f32_16x16x32_bf16 v[12:15], v[48:51], v[188:191], v[12:15]
    s_waitcnt lgkmcnt(10)
    v_mfma_f32_32x32x16_bf16 v[80:95], v[44:47], v[188:191], v[80:95]
    ds_read_b64_tr_b16 v[36:37], v9 offset:20480
    ds_read_b64_tr_b16 v[38:39], v9 offset:21504
    s_waitcnt lgkmcnt(10)
    v_mfma_f32_32x32x16_bf16 v[64:79], v[16:19], v[192:195], v[64:79]
    ds_read_b64_tr_b16 v[40:41], v8 offset:22528
    ds_read_b64_tr_b16 v[42:43], v8 offset:23552
    v_mfma_f32_16x16x32_bf16 v[12:15], v[48:51], v[192:195], v[12:15]
    s_waitcnt lgkmcnt(10)
    v_mfma_f32_32x32x16_bf16 v[80:95], v[20:23], v[192:195], v[80:95]
    ds_read_b64_tr_b16 v[44:45], v9 offset:22528
    ds_read_b64_tr_b16 v[46:47], v9 offset:23552
    s_waitcnt lgkmcnt(10)
    v_mfma_f32_32x32x16_bf16 v[64:79], v[24:27], v[196:199], v[64:79]
    ds_read_b64_tr_b16 v[16:17], v8 offset:24576
    ds_read_b64_tr_b16 v[18:19], v8 offset:25600
    ds_read_b32 v6, v4
    v_mfma_f32_16x16x32_bf16 v[12:15], v[48:51], v[196:199], v[12:15]
    s_waitcnt lgkmcnt(11)
    v_mfma_f32_32x32x16_bf16 v[80:95], v[28:31], v[196:199], v[80:95]
    ds_read_b64_tr_b16 v[20:21], v9 offset:24576
    ds_read_b64_tr_b16 v[22:23], v9 offset:25600
    s_waitcnt lgkmcnt(11)
    v_mfma_f32_32x32x16_bf16 v[64:79], v[32:35], v[200:203], v[64:79]
    ds_read_b64_tr_b16 v[24:25], v8 offset:26624
    ds_read_b64_tr_b16 v[26:27], v8 offset:27648
    v_mfma_f32_16x16x32_bf16 v[12:15], v[48:51], v[200:203], v[12:15]
    s_waitcnt lgkmcnt(11)
    v_mfma_f32_32x32x16_bf16 v[80:95], v[36:39], v[200:203], v[80:95]
    ds_read_b64_tr_b16 v[28:29], v9 offset:26624
    ds_read_b64_tr_b16 v[30:31], v9 offset:27648
    s_waitcnt lgkmcnt(11)
    v_mfma_f32_32x32x16_bf16 v[64:79], v[40:43], v[204:207], v[64:79]
    ds_read_b64_tr_b16 v[32:33], v8 offset:28672
    ds_read_b64_tr_b16 v[34:35], v8 offset:29696
    v_mfma_f32_16x16x32_bf16 v[12:15], v[48:51], v[204:207], v[12:15]
    s_waitcnt lgkmcnt(11)
    v_mfma_f32_32x32x16_bf16 v[80:95], v[44:47], v[204:207], v[80:95]
    ds_read_b64_tr_b16 v[36:37], v9 offset:28672
    ds_read_b64_tr_b16 v[38:39], v9 offset:29696
    s_waitcnt lgkmcnt(10)
    v_cmp_gt_u32 vcc, 12, v6
    v_mfma_f32_32x32x16_bf16 v[64:79], v[16:19], v[208:211], v[64:79]
    ds_read_b64_tr_b16 v[40:41], v8 offset:30720
    ds_read_b64_tr_b16 v[42:43], v8 offset:31744
    v_mfma_f32_16x16x32_bf16 v[12:15], v[48:51], v[208:211], v[12:15]
    s_waitcnt lgkmcnt(10)
    v_mfma_f32_32x32x16_bf16 v[80:95], v[20:23], v[208:211], v[80:95]
    ds_read_b64_tr_b16 v[44:45], v9 offset:30720
    ds_read_b64_tr_b16 v[46:47], v9 offset:31744
    s_waitcnt lgkmcnt(10)
    v_mfma_f32_32x32x16_bf16 v[64:79], v[24:27], v[212:215], v[64:79]
    s_cbranch_vccnz L_sp_v3
L_ok_v3:
    ds_read_b64_tr_b16 v[16:17], v8 offset:32768
    ds_read_b64_tr_b16 v[18:19], v8 offset:33792
    v_mfma_f32_16x16x32_bf16 v[12:15], v[48:51], v[212:215], v[12:15]
    s_waitcnt lgkmcnt(10)
    v_mfma_f32_32x32x16_bf16 v[80:95], v[28:31], v[212:215], v[80:95]
    ds_read_b64_tr_b16 v[20:21], v9 offset:32768
    ds_read_b64_tr_b16 v[22:23], v9 offset:33792
    s_waitcnt lgkmcnt(10)
    v_mfma_f32_32x32x16_bf16 v[64:79], v[32:35], v[216:219], v[64:79]
    ds_read_b64_tr_b16 v[24:25], v8 offset:34816
    ds_read_b64_tr_b16 v[26:27], v8 offset:35840
    v_mfma_f32_16x16x32_bf16 v[12:15], v[48:51], v[216:219], v[12:15]
    s_waitcnt lgkmcnt(10)
    v_mfma_f32_32x32x16_bf16 v[80:95], v[36:39], v[216:219], v[80:95]
    ds_read_b64_tr_b16 v[28:29], v9 offset:34816
    ds_read_b64_tr_b16 v[30:31], v9 offset:35840
    s_waitcnt lgkmcnt(10)
    v_mfma_f32_32x32x16_bf16 v[64:79], v[40:43], v[220:223], v[64:79]
    ds_read_b64_tr_b16 v[32:33], v8 offset:36864
    ds_read_b64_tr_b16 v[34:35], v8 offset:37888
    v_mfma_f32_16x16x32_bf16 v[12:15], v[48:51], v[220:223], v[12:15]
    s_waitcnt lgkmcnt(10)
    v_mfma_f32_32x32x16_bf16 v[80:95], v[44:47], v[220:223], v[80:95]
    ds_read_b64_tr_b16 v[36:37], v9 offset:36864
    ds_read_b64_tr_b16 v[38:39], v9 offset:37888
    s_waitcnt lgkmcnt(10)
    v_mfma_f32_32x32x16_bf16 v[64:79], v[16:19], v[224:227], v[64:79]
    ds_read_b64_tr_b16 v[40:41], v8 offset:38912
    ds_read_b64_tr_b16 v[42:43], v8 offset:39936
    v_mfma_f32_16x16x32_bf16 v[12:15], v[48:51], v[224:227], v[12:15]
    s_waitcnt lgkmcnt(10)
    v_mfma_f32_32x32x16_bf16 v[80:95], v[20:23], v[224:227], v[80:95]
    ds_read_b64_tr_b16 v[44:45], v9 offset:38912
    ds_read_b64_tr_b16 v[46:47], v9 offset:39936
    s_waitcnt lgkmcnt(10)
    v_mfma_f32_32x32x16_bf16 v[64:79], v[24:27], v[228:231], v[64:79]
    ds_read_b64_tr_b16 v[16:17], v8 offset:40960
    ds_read_b64_tr_b16 v[18:19], v8 offset:41984
    ds_read_b32 v6, v4
    v_mfma_f32_16x16x32_bf16 v[12:15], v[48:51], v[228:231], v[12:15]
    s_waitcnt lgkmcnt(11)
    v_mfma_f32_32x32x16_bf16 v[80:95], v[28:31], v[228:231], v[80:95]
    ds_read_b64_tr_b16 v[20:21], v9 offset:40960
    ds_read_b64_tr_b16 v[22:23], v9 offset:41984
    s_waitcnt lgkmcnt(11)
    v_mfma_f32_32x32x16_bf16 v[64:79], v[32:35], v[232:235], v[64:79]
    ds_read_b64_tr_b16 v[24:25], v8 offset:43008
    ds_read_b64_tr_b16 v[26:27], v8 offset:44032
    v_mfma_f32_16x16x32_bf16 v[12:15], v[48:51], v[232:235], v[12:15]
    s_waitcnt lgkmcnt(11)
    v_mfma_f32_32x32x16_bf16 v[80:95], v[36:39], v[232:235], v[80:95]
    ds_read_b64_tr_b16 v[28:29], v9 offset:43008
    ds_read_b64_tr_b16 v[30:31], v9 offset:44032
    s_waitcnt lgkmcnt(11)
    v_mfma_f32_32x32x16_bf16 v[64:79], v[40:43], v[236:239], v[64:79]
    ds_read_b64_tr_b16 v[32:33], v8 offset:45056
    ds_read_b64_tr_b16 v[34:35], v8 offset:46080
    v_mfma_f32_16x16x32_bf16 v[12:15], v[48:51], v[236:239], v[12:15]
    s_waitcnt lgkmcnt(11)
    v_mfma_f32_32x32x16_bf16 v[80:95], v[44:47], v[236:239], v[80:95]
    ds_read_b64_tr_b16 v[36:37], v9 offset:45056
    ds_read_b64_tr_b16 v[38:39], v9 offset:46080
    s_waitcnt lgkmcnt(10)
    v_cmp_gt_u32 vcc, 13, v6
    v_mfma_f32_32x32x16_bf16 v[64:79], v[16:19], v[240:243], v[64:79]
    ds_read_b64_tr_b16 v[40:41], v8 offset:47104
    ds_read_b64_tr_b16 v[42:43], v8 offset:48128
    v_mfma_f32_16x16x32_bf16 v[12:15], v[48:51], v[240:243], v[12:15]
    s_waitcnt lgkmcnt(10)
    v_mfma_f32_32x32x16_bf16 v[80:95], v[20:23], v[240:243], v[80:95]
    ds_read_b64_tr_b16 v[44:45], v9 offset:47104
    ds_read_b64_tr_b16 v[46:47], v9 offset:48128
    s_waitcnt lgkmcnt(10)
    v_mfma_f32_32x32x16_bf16 v[64:79], v[24:27], v[244:247], v[64:79]
    s_cbranch_vccnz L_sp_v4
L_ok_v4:
    ds_read_b64_tr_b16 v[16:17], v8 offset:49152
    ds_read_b64_tr_b16 v[18:19], v8 offset:50176
    v_mfma_f32_16x16x32_bf16 v[12:15], v[48:51], v[244:247], v[12:15]
    s_waitcnt lgkmcnt(10)
    v_mfma_f32_32x32x16_bf16 v[80:95], v[28:31], v[244:247], v[80:95]
    ds_read_b64_tr_b16 v[20:21], v9 offset:49152
    ds_read_b64_tr_b16 v[22:23], v9 offset:50176
    s_waitcnt lgkmcnt(10)
    v_mfma_f32_32x32x16_bf16 v[64:79], v[32:35], v[248:251], v[64:79]
    ds_read_b64_tr_b16 v[24:25], v8 offset:51200
    ds_read_b64_tr_b16 v[26:27], v8 offset:52224
    v_mfma_f32_16x16x32_bf16 v[12:15], v[48:51], v[248:251], v[12:15]
    s_waitcnt lgkmcnt(10)
    v_mfma_f32_32x32x16_bf16 v[80:95], v[36:39], v[248:251], v[80:95]
    ds_read_b64_tr_b16 v[28:29], v9 offset:51200
    ds_read_b64_tr_b16 v[30:31], v9 offset:52224
    s_waitcnt lgkmcnt(10)
    v_mfma_f32_32x32x16_bf16 v[64:79], v[40:43], v[252:255], v[64:79]
    ds_read_b64_tr_b16 v[32:33], v8 offset:53248
    ds_read_b64_tr_b16 v[34:35], v8 offset:54272
    v_mfma_f32_16x16x32_bf16 v[12:15], v[48:51], v[252:255], v[12:15]
    s_waitcnt lgkmcnt(10)
    v_mfma_f32_32x32x16_bf16 v[80:95], v[44:47], v[252:255], v[80:95]
    ds_read_b64_tr_b16 v[36:37], v9 offset:53248
    ds_read_b64_tr_b16 v[38:39], v9 offset:54272
    s_mov_b64 s[74:75], vcc
    ds_read_b32 v2, v4 offset:16
    v_and_b32 v0, 15, v7
    v_lshlrev_b32 v0, 2, v0
    v_bfe_u32 v1, v7, 4, 1
    v_cmp_eq_u32 s[72:73], 1, v1
    s_nop 3
    ds_bpermute_b32 v53, v0, v12
    ds_bpermute_b32 v54, v0, v13
    s_waitcnt lgkmcnt(0)
    v_cndmask_b32 v53, v53, v54, s[72:73]
    v_cmp_gt_u32 vcc, 11, v2
    v_rcp_f32 v52, v53
    s_nop 1
    s_cbranch_vccnz L_sp_o
L_ok_o:
    v_mul_f32 v64, v64, v52
    v_mul_f32 v65, v65, v52
    v_mul_f32 v66, v66, v52
    v_mul_f32 v67, v67, v52
    v_cvt_pk_bf16_f32 v54, v64, v65
    v_cvt_pk_bf16_f32 v55, v66, v67
    v_xor_b32 v0, 0, v11
    ds_write_b64 v0, v[54:55]
    v_mul_f32 v68, v68, v52
    v_mul_f32 v69, v69, v52
    v_mul_f32 v70, v70, v52
    v_mul_f32 v71, v71, v52
    v_cvt_pk_bf16_f32 v56, v68, v69
    v_cvt_pk_bf16_f32 v57, v70, v71
    v_xor_b32 v0, 16, v11
    ds_write_b64 v0, v[56:57]
    v_mul_f32 v72, v72, v52
    v_mul_f32 v73, v73, v52
    v_mul_f32 v74, v74, v52
    v_mul_f32 v75, v75, v52
    v_cvt_pk_bf16_f32 v58, v72, v73
    v_cvt_pk_bf16_f32 v59, v74, v75
    v_xor_b32 v0, 32, v11
    ds_write_b64 v0, v[58:59]
    v_mul_f32 v76, v76, v52
    v_mul_f32 v77, v77, v52
    v_mul_f32 v78, v78, v52
    v_mul_f32 v79, v79, v52
    v_cvt_pk_bf16_f32 v60, v76, v77
    v_cvt_pk_bf16_f32 v61, v78, v79
    v_xor_b32 v0, 48, v11
    ds_write_b64 v0, v[60:61]
    v_mul_f32 v80, v80, v52
    v_mul_f32 v81, v81, v52
    v_mul_f32 v82, v82, v52
    v_mul_f32 v83, v83, v52
    v_cvt_pk_bf16_f32 v54, v80, v81
    v_cvt_pk_bf16_f32 v55, v82, v83
    v_xor_b32 v0, 64, v11
    ds_write_b64 v0, v[54:55]
    v_mul_f32 v84, v84, v52
    v_mul_f32 v85, v85, v52
    v_mul_f32 v86, v86, v52
    v_mul_f32 v87, v87, v52
    v_cvt_pk_bf16_f32 v56, v84, v85
    v_cvt_pk_bf16_f32 v57, v86, v87
    v_xor_b32 v0, 80, v11
    ds_write_b64 v0, v[56:57]
    v_mul_f32 v88, v88, v52
    v_mul_f32 v89, v89, v52
    v_mul_f32 v90, v90, v52
    v_mul_f32 v91, v91, v52
    v_cvt_pk_bf16_f32 v58, v88, v89
    v_cvt_pk_bf16_f32 v59, v90, v91
    v_xor_b32 v0, 96, v11
    ds_write_b64 v0, v[58:59]
    v_mul_f32 v92, v92, v52
    v_mul_f32 v93, v93, v52
    v_mul_f32 v94, v94, v52
    v_mul_f32 v95, v95, v52
    v_cvt_pk_bf16_f32 v60, v92, v93
    v_cvt_pk_bf16_f32 v61, v94, v95
    v_xor_b32 v0, 112, v11
    ds_write_b64 v0, v[60:61]
    v_mov_b32 v1, 1
    s_waitcnt lgkmcnt(0)
    ds_write_b32 v10, v1
    s_mov_b64 vcc, s[74:75]
    v_mfma_f32_32x32x16_bf16 v[96:111], v[16:19], v[128:131], 0
    ds_read_b64_tr_b16 v[40:41], v8 offset:55296
    ds_read_b64_tr_b16 v[42:43], v8 offset:56320
    v_mfma_f32_32x32x16_bf16 v[112:127], v[20:23], v[128:131], 0
    ds_read_b64_tr_b16 v[44:45], v9 offset:55296
    ds_read_b64_tr_b16 v[46:47], v9 offset:56320
    v_mfma_f32_32x32x16_bf16 v[96:111], v[24:27], v[132:135], v[96:111]
    ds_read_b64_tr_b16 v[16:17], v8 offset:57344
    ds_read_b64_tr_b16 v[18:19], v8 offset:58368
    ds_read_b32 v6, v4
    v_mfma_f32_32x32x16_bf16 v[112:127], v[28:31], v[132:135], v[112:127]
    ds_read_b64_tr_b16 v[20:21], v9 offset:57344
    ds_read_b64_tr_b16 v[22:23], v9 offset:58368
    v_mfma_f32_32x32x16_bf16 v[96:111], v[32:35], v[136:139], v[96:111]
    ds_read_b64_tr_b16 v[24:25], v8 offset:59392
    ds_read_b64_tr_b16 v[26:27], v8 offset:60416
    v_mfma_f32_32x32x16_bf16 v[112:127], v[36:39], v[136:139], v[112:127]
    ds_read_b64_tr_b16 v[28:29], v9 offset:59392
    ds_read_b64_tr_b16 v[30:31], v9 offset:60416
    s_waitcnt lgkmcnt(11)
    v_mfma_f32_32x32x16_bf16 v[96:111], v[40:43], v[140:143], v[96:111]
    ds_read_b64_tr_b16 v[32:33], v8 offset:61440
    ds_read_b64_tr_b16 v[34:35], v8 offset:62464
    s_waitcnt lgkmcnt(11)
    v_mfma_f32_32x32x16_bf16 v[112:127], v[44:47], v[140:143], v[112:127]
    ds_read_b64_tr_b16 v[36:37], v9 offset:61440
    ds_read_b64_tr_b16 v[38:39], v9 offset:62464
    s_waitcnt lgkmcnt(10)
    v_cmp_gt_u32 vcc, 14, v6
    v_mfma_f32_32x32x16_bf16 v[96:111], v[16:19], v[144:147], v[96:111]
    ds_read_b64_tr_b16 v[40:41], v8 offset:63488
    ds_read_b64_tr_b16 v[42:43], v8 offset:64512
    s_waitcnt lgkmcnt(10)
    v_mfma_f32_32x32x16_bf16 v[112:127], v[20:23], v[144:147], v[112:127]
    ds_read_b64_tr_b16 v[44:45], v9 offset:63488
    ds_read_b64_tr_b16 v[46:47], v9 offset:64512
    s_waitcnt lgkmcnt(10)
    v_mfma_f32_32x32x16_bf16 v[96:111], v[24:27], v[148:151], v[96:111]
    s_cbranch_vccnz L_sp_v5
L_ok_v5:
    v_add_u32 v8, 0x10000, v8
    ds_read_b64_tr_b16 v[16:17], v8 offset:0
    ds_read_b64_tr_b16 v[18:19], v8 offset:1024
    s_waitcnt lgkmcnt(10)
    v_mfma_f32_32x32x16_bf16 v[112:127], v[28:31], v[148:151], v[112:127]
    v_add_u32 v9, 0x10000, v9
    ds_read_b64_tr_b16 v[20:21], v9 offset:0
    ds_read_b64_tr_b16 v[22:23], v9 offset:1024
    s_waitcnt lgkmcnt(10)
    v_mfma_f32_32x32x16_bf16 v[96:111], v[32:35], v[152:155], v[96:111]
    ds_read_b64_tr_b16 v[24:25], v8 offset:2048
    ds_read_b64_tr_b16 v[26:27], v8 offset:3072
    s_waitcnt lgkmcnt(10)
    v_mfma_f32_32x32x16_bf16 v[112:127], v[36:39], v[152:155], v[112:127]
    ds_read_b64_tr_b16 v[28:29], v9 offset:2048
    ds_read_b64_tr_b16 v[30:31], v9 offset:3072
    s_waitcnt lgkmcnt(10)
    v_mfma_f32_32x32x16_bf16 v[96:111], v[40:43], v[156:159], v[96:111]
    ds_read_b64_tr_b16 v[32:33], v8 offset:4096
    ds_read_b64_tr_b16 v[34:35], v8 offset:5120
    s_waitcnt lgkmcnt(10)
    v_mfma_f32_32x32x16_bf16 v[112:127], v[44:47], v[156:159], v[112:127]
    ds_read_b64_tr_b16 v[36:37], v9 offset:4096
    ds_read_b64_tr_b16 v[38:39], v9 offset:5120
    s_waitcnt lgkmcnt(10)
    v_mfma_f32_32x32x16_bf16 v[96:111], v[16:19], v[160:163], v[96:111]
    ds_read_b64_tr_b16 v[40:41], v8 offset:6144
    ds_read_b64_tr_b16 v[42:43], v8 offset:7168
    s_waitcnt lgkmcnt(10)
    v_mfma_f32_32x32x16_bf16 v[112:127], v[20:23], v[160:163], v[112:127]
    ds_read_b64_tr_b16 v[44:45], v9 offset:6144
    ds_read_b64_tr_b16 v[46:47], v9 offset:7168
    s_waitcnt lgkmcnt(10)
    v_mfma_f32_32x32x16_bf16 v[96:111], v[24:27], v[164:167], v[96:111]
    ds_read_b64_tr_b16 v[16:17], v8 offset:8192
    ds_read_b64_tr_b16 v[18:19], v8 offset:9216
    ds_read_b32 v6, v4
    s_waitcnt lgkmcnt(11)
    v_mfma_f32_32x32x16_bf16 v[112:127], v[28:31], v[164:167], v[112:127]
    ds_read_b64_tr_b16 v[20:21], v9 offset:8192
    ds_read_b64_tr_b16 v[22:23], v9 offset:9216
    s_waitcnt lgkmcnt(11)
    v_mfma_f32_32x32x16_bf16 v[96:111], v[32:35], v[168:171], v[96:111]
    ds_read_b64_tr_b16 v[24:25], v8 offset:10240
    ds_read_b64_tr_b16 v[26:27], v8 offset:11264
    s_waitcnt lgkmcnt(11)
    v_mfma_f32_32x32x16_bf16 v[112:127], v[36:39], v[168:171], v[112:127]
    ds_read_b64_tr_b16 v[28:29], v9 offset:10240
    ds_read_b64_tr_b16 v[30:31], v9 offset:11264
    s_waitcnt lgkmcnt(11)
    v_mfma_f32_32x32x16_bf16 v[96:111], v[40:43], v[172:175], v[96:111]
    ds_read_b64_tr_b16 v[32:33], v8 offset:12288
    ds_read_b64_tr_b16 v[34:35], v8 offset:13312
    s_waitcnt lgkmcnt(11)
    v_mfma_f32_32x32x16_bf16 v[112:127], v[44:47], v[172:175], v[112:127]
    ds_read_b64_tr_b16 v[36:37], v9 offset:12288
    ds_read_b64_tr_b16 v[38:39], v9 offset:13312
    s_waitcnt lgkmcnt(10)
    v_cmp_gt_u32 vcc, 15, v6
    v_mfma_f32_32x32x16_bf16 v[96:111], v[16:19], v[176:179], v[96:111]
    ds_read_b64_tr_b16 v[40:41], v8 offset:14336
    ds_read_b64_tr_b16 v[42:43], v8 offset:15360
    s_waitcnt lgkmcnt(10)
    v_mfma_f32_32x32x16_bf16 v[112:127], v[20:23], v[176:179], v[112:127]
    ds_read_b64_tr_b16 v[44:45], v9 offset:14336
    ds_read_b64_tr_b16 v[46:47], v9 offset:15360
    s_waitcnt lgkmcnt(10)
    v_mfma_f32_32x32x16_bf16 v[96:111], v[24:27], v[180:183], v[96:111]
    s_cbranch_vccnz L_sp_v6
L_ok_v6:
    ds_read_b64_tr_b16 v[16:17], v8 offset:16384
    ds_read_b64_tr_b16 v[18:19], v8 offset:17408
    s_waitcnt lgkmcnt(10)
    v_mfma_f32_32x32x16_bf16 v[112:127], v[28:31], v[180:183], v[112:127]
    ds_read_b64_tr_b16 v[20:21], v9 offset:16384
    ds_read_b64_tr_b16 v[22:23], v9 offset:17408
    s_waitcnt lgkmcnt(10)
    v_mfma_f32_32x32x16_bf16 v[96:111], v[32:35], v[184:187], v[96:111]
    ds_read_b64_tr_b16 v[24:25], v8 offset:18432
    ds_read_b64_tr_b16 v[26:27], v8 offset:19456
    s_waitcnt lgkmcnt(10)
    v_mfma_f32_32x32x16_bf16 v[112:127], v[36:39], v[184:187], v[112:127]
    ds_read_b64_tr_b16 v[28:29], v9 offset:18432
    ds_read_b64_tr_b16 v[30:31], v9 offset:19456
    s_waitcnt lgkmcnt(10)
    v_mfma_f32_32x32x16_bf16 v[96:111], v[40:43], v[188:191], v[96:111]
    ds_read_b64_tr_b16 v[32:33], v8 offset:20480
    ds_read_b64_tr_b16 v[34:35], v8 offset:21504
    s_waitcnt lgkmcnt(10)
    v_mfma_f32_32x32x16_bf16 v[112:127], v[44:47], v[188:191], v[112:127]
    ds_read_b64_tr_b16 v[36:37], v9 offset:20480
    ds_read_b64_tr_b16 v[38:39], v9 offset:21504
    s_waitcnt lgkmcnt(10)
    v_mfma_f32_32x32x16_bf16 v[96:111], v[16:19], v[192:195], v[96:111]
    ds_read_b64_tr_b16 v[40:41], v8 offset:22528
    ds_read_b64_tr_b16 v[42:43], v8 offset:23552
    s_waitcnt lgkmcnt(10)
    v_mfma_f32_32x32x16_bf16 v[112:127], v[20:23], v[192:195], v[112:127]
    ds_read_b64_tr_b16 v[44:45], v9 offset:22528
    ds_read_b64_tr_b16 v[46:47], v9 offset:23552
    s_waitcnt lgkmcnt(10)
    v_mfma_f32_32x32x16_bf16 v[96:111], v[24:27], v[196:199], v[96:111]
    ds_read_b64_tr_b16 v[16:17], v8 offset:24576
    ds_read_b64_tr_b16 v[18:19], v8 offset:25600
    ds_read_b32 v6, v4
    s_waitcnt lgkmcnt(11)
    v_mfma_f32_32x32x16_bf16 v[112:127], v[28:31], v[196:199], v[112:127]
    ds_read_b64_tr_b16 v[20:21], v9 offset:24576
    ds_read_b64_tr_b16 v[22:23], v9 offset:25600
    s_waitcnt lgkmcnt(11)
    v_mfma_f32_32x32x16_bf16 v[96:111], v[32:35], v[200:203], v[96:111]
    ds_read_b64_tr_b16 v[24:25], v8 offset:26624
    ds_read_b64_tr_b16 v[26:27], v8 offset:27648
    s_waitcnt lgkmcnt(11)
    v_mfma_f32_32x32x16_bf16 v[112:127], v[36:39], v[200:203], v[112:127]
    ds_read_b64_tr_b16 v[28:29], v9 offset:26624
    ds_read_b64_tr_b16 v[30:31], v9 offset:27648
    s_waitcnt lgkmcnt(11)
    v_mfma_f32_32x32x16_bf16 v[96:111], v[40:43], v[204:207], v[96:111]
    ds_read_b64_tr_b16 v[32:33], v8 offset:28672
    ds_read_b64_tr_b16 v[34:35], v8 offset:29696
    s_waitcnt lgkmcnt(11)
    v_mfma_f32_32x32x16_bf16 v[112:127], v[44:47], v[204:207], v[112:127]
    ds_read_b64_tr_b16 v[36:37], v9 offset:28672
    ds_read_b64_tr_b16 v[38:39], v9 offset:29696
    s_waitcnt lgkmcnt(10)
    v_cmp_gt_u32 vcc, 16, v6
    v_mfma_f32_32x32x16_bf16 v[96:111], v[16:19], v[208:211], v[96:111]
    ds_read_b64_tr_b16 v[40:41], v8 offset:30720
    ds_read_b64_tr_b16 v[42:43], v8 offset:31744
    s_waitcnt lgkmcnt(10)
    v_mfma_f32_32x32x16_bf16 v[112:127], v[20:23], v[208:211], v[112:127]
    ds_read_b64_tr_b16 v[44:45], v9 offset:30720
    ds_read_b64_tr_b16 v[46:47], v9 offset:31744
    s_waitcnt lgkmcnt(10)
    v_mfma_f32_32x32x16_bf16 v[96:111], v[24:27], v[212:215], v[96:111]
    s_cbranch_vccnz L_sp_v7
L_ok_v7:
    ds_read_b64_tr_b16 v[16:17], v8 offset:32768
    ds_read_b64_tr_b16 v[18:19], v8 offset:33792
    s_waitcnt lgkmcnt(10)
    v_mfma_f32_32x32x16_bf16 v[112:127], v[28:31], v[212:215], v[112:127]
    ds_read_b64_tr_b16 v[20:21], v9 offset:32768
    ds_read_b64_tr_b16 v[22:23], v9 offset:33792
    s_waitcnt lgkmcnt(10)
    v_mfma_f32_32x32x16_bf16 v[96:111], v[32:35], v[216:219], v[96:111]
    ds_read_b64_tr_b16 v[24:25], v8 offset:34816
    ds_read_b64_tr_b16 v[26:27], v8 offset:35840
    s_waitcnt lgkmcnt(10)
    v_mfma_f32_32x32x16_bf16 v[112:127], v[36:39], v[216:219], v[112:127]
    ds_read_b64_tr_b16 v[28:29], v9 offset:34816
    ds_read_b64_tr_b16 v[30:31], v9 offset:35840
    s_waitcnt lgkmcnt(10)
    v_mfma_f32_32x32x16_bf16 v[96:111], v[40:43], v[220:223], v[96:111]
    ds_read_b64_tr_b16 v[32:33], v8 offset:36864
    ds_read_b64_tr_b16 v[34:35], v8 offset:37888
    s_waitcnt lgkmcnt(10)
    v_mfma_f32_32x32x16_bf16 v[112:127], v[44:47], v[220:223], v[112:127]
    ds_read_b64_tr_b16 v[36:37], v9 offset:36864
    ds_read_b64_tr_b16 v[38:39], v9 offset:37888
    s_waitcnt lgkmcnt(10)
    v_mfma_f32_32x32x16_bf16 v[96:111], v[16:19], v[224:227], v[96:111]
    ds_read_b64_tr_b16 v[40:41], v8 offset:38912
    ds_read_b64_tr_b16 v[42:43], v8 offset:39936
    s_waitcnt lgkmcnt(10)
    v_mfma_f32_32x32x16_bf16 v[112:127], v[20:23], v[224:227], v[112:127]
    ds_read_b64_tr_b16 v[44:45], v9 offset:38912
    ds_read_b64_tr_b16 v[46:47], v9 offset:39936
    s_waitcnt lgkmcnt(10)
    v_mfma_f32_32x32x16_bf16 v[96:111], v[24:27], v[228:231], v[96:111]
    ds_read_b64_tr_b16 v[16:17], v8 offset:40960
    ds_read_b64_tr_b16 v[18:19], v8 offset:41984
    s_waitcnt lgkmcnt(10)
    v_mfma_f32_32x32x16_bf16 v[112:127], v[28:31], v[228:231], v[112:127]
    ds_read_b64_tr_b16 v[20:21], v9 offset:40960
    ds_read_b64_tr_b16 v[22:23], v9 offset:41984
    s_waitcnt lgkmcnt(10)
    v_mfma_f32_32x32x16_bf16 v[96:111], v[32:35], v[232:235], v[96:111]
    ds_read_b64_tr_b16 v[24:25], v8 offset:43008
    ds_read_b64_tr_b16 v[26:27], v8 offset:44032
    s_waitcnt lgkmcnt(10)
    v_mfma_f32_32x32x16_bf16 v[112:127], v[36:39], v[232:235], v[112:127]
    ds_read_b64_tr_b16 v[28:29], v9 offset:43008
    ds_read_b64_tr_b16 v[30:31], v9 offset:44032
    s_waitcnt lgkmcnt(10)
    v_mfma_f32_32x32x16_bf16 v[96:111], v[40:43], v[236:239], v[96:111]
    ds_read_b64_tr_b16 v[32:33], v8 offset:45056
    ds_read_b64_tr_b16 v[34:35], v8 offset:46080
    s_waitcnt lgkmcnt(10)
    v_mfma_f32_32x32x16_bf16 v[112:127], v[44:47], v[236:239], v[112:127]
    ds_read_b64_tr_b16 v[36:37], v9 offset:45056
    ds_read_b64_tr_b16 v[38:39], v9 offset:46080
    s_waitcnt lgkmcnt(10)
    v_mfma_f32_32x32x16_bf16 v[96:111], v[16:19], v[240:243], v[96:111]
    ds_read_b64_tr_b16 v[40:41], v8 offset:47104
    ds_read_b64_tr_b16 v[42:43], v8 offset:48128
    s_waitcnt lgkmcnt(10)
    v_mfma_f32_32x32x16_bf16 v[112:127], v[20:23], v[240:243], v[112:127]
    ds_read_b64_tr_b16 v[44:45], v9 offset:47104
    ds_read_b64_tr_b16 v[46:47], v9 offset:48128
    s_waitcnt lgkmcnt(10)
    v_mfma_f32_32x32x16_bf16 v[96:111], v[24:27], v[244:247], v[96:111]
    s_waitcnt lgkmcnt(8)
    v_mfma_f32_32x32x16_bf16 v[112:127], v[28:31], v[244:247], v[112:127]
    s_waitcnt lgkmcnt(6)
    v_mfma_f32_32x32x16_bf16 v[96:111], v[32:35], v[248:251], v[96:111]
    s_waitcnt lgkmcnt(4)
    v_mfma_f32_32x32x16_bf16 v[112:127], v[36:39], v[248:251], v[112:127]
    s_waitcnt lgkmcnt(2)
    v_mfma_f32_32x32x16_bf16 v[96:111], v[40:43], v[252:255], v[96:111]
    s_waitcnt lgkmcnt(0)
    v_mfma_f32_32x32x16_bf16 v[112:127], v[44:47], v[252:255], v[112:127]
    s_nop 7
    s_nop 3
    v_mul_f32 v96, v96, v52
    v_mul_f32 v97, v97, v52
    v_mul_f32 v98, v98, v52
    v_mul_f32 v99, v99, v52
    v_cvt_pk_bf16_f32 v54, v96, v97
    v_cvt_pk_bf16_f32 v55, v98, v99
    v_xor_b32 v0, 128, v11
    ds_write_b64 v0, v[54:55]
    v_mul_f32 v100, v100, v52
    v_mul_f32 v101, v101, v52
    v_mul_f32 v102, v102, v52
    v_mul_f32 v103, v103, v52
    v_cvt_pk_bf16_f32 v56, v100, v101
    v_cvt_pk_bf16_f32 v57, v102, v103
    v_xor_b32 v0, 144, v11
    ds_write_b64 v0, v[56:57]
    v_mul_f32 v104, v104, v52
    v_mul_f32 v105, v105, v52
    v_mul_f32 v106, v106, v52
    v_mul_f32 v107, v107, v52
    v_cvt_pk_bf16_f32 v58, v104, v105
    v_cvt_pk_bf16_f32 v59, v106, v107
    v_xor_b32 v0, 160, v11
    ds_write_b64 v0, v[58:59]
    v_mul_f32 v108, v108, v52
    v_mul_f32 v109, v109, v52
    v_mul_f32 v110, v110, v52
    v_mul_f32 v111, v111, v52
    v_cvt_pk_bf16_f32 v60, v108, v109
    v_cvt_pk_bf16_f32 v61, v110, v111
    v_xor_b32 v0, 176, v11
    ds_write_b64 v0, v[60:61]
    v_mul_f32 v112, v112, v52
    v_mul_f32 v113, v113, v52
    v_mul_f32 v114, v114, v52
    v_mul_f32 v115, v115, v52
    v_cvt_pk_bf16_f32 v54, v112, v113
    v_cvt_pk_bf16_f32 v55, v114, v115
    v_xor_b32 v0, 192, v11
    ds_write_b64 v0, v[54:55]
    v_mul_f32 v116, v116, v52
    v_mul_f32 v117, v117, v52
    v_mul_f32 v118, v118, v52
    v_mul_f32 v119, v119, v52
    v_cvt_pk_bf16_f32 v56, v116, v117
    v_cvt_pk_bf16_f32 v57, v118, v119
    v_xor_b32 v0, 208, v11
    ds_write_b64 v0, v[56:57]
    v_mul_f32 v120, v120, v52
    v_mul_f32 v121, v121, v52
    v_mul_f32 v122, v122, v52
    v_mul_f32 v123, v123, v52
    v_cvt_pk_bf16_f32 v58, v120, v121
    v_cvt_pk_bf16_f32 v59, v122, v123
    v_xor_b32 v0, 224, v11
    ds_write_b64 v0, v[58:59]
    v_mul_f32 v124, v124, v52
    v_mul_f32 v125, v125, v52
    v_mul_f32 v126, v126, v52
    v_mul_f32 v127, v127, v52
    v_cvt_pk_bf16_f32 v60, v124, v125
    v_cvt_pk_bf16_f32 v61, v126, v127
    v_xor_b32 v0, 240, v11
    ds_write_b64 v0, v[60:61]
    v_mov_b32 v1, 2
    s_waitcnt lgkmcnt(0)
    ds_write_b32 v10, v1
    s_waitcnt lgkmcnt(0)
    s_endpgm
L_rare_0:
    s_getpc_b64 s[78:79]
L_rarepc_0:
    s_add_u32 s78, s78, L_rescale-L_rarepc_0
    s_addc_u32 s79, s79, 0
    s_swappc_b64 s[76:77], s[78:79]
    s_branch L_back_0
L_rare_1:
    s_getpc_b64 s[78:79]
L_rarepc_1:
    s_add_u32 s78, s78, L_rescale-L_rarepc_1
    s_addc_u32 s79, s79, 0
    s_swappc_b64 s[76:77], s[78:79]
    s_branch L_back_1
L_rare_2:
    s_getpc_b64 s[78:79]
L_rarepc_2:
    s_add_u32 s78, s78, L_rescale-L_rarepc_2
    s_addc_u32 s79, s79, 0
    s_swappc_b64 s[76:77], s[78:79]
    s_branch L_back_2
L_rare_3:
    s_getpc_b64 s[78:79]
L_rarepc_3:
    s_add_u32 s78, s78, L_rescale-L_rarepc_3
    s_addc_u32 s79, s79, 0
    s_swappc_b64 s[76:77], s[78:79]
    s_branch L_back_3
L_rare_4:
    s_getpc_b64 s[78:79]
L_rarepc_4:
    s_add_u32 s78, s78, L_rescale-L_rarepc_4
    s_addc_u32 s79, s79, 0
    s_swappc_b64 s[76:77], s[78:79]
    s_branch L_back_4
L_rare_5:
    s_getpc_b64 s[78:79]
L_rarepc_5:
    s_add_u32 s78, s78, L_rescale-L_rarepc_5
    s_addc_u32 s79, s79, 0
    s_swappc_b64 s[76:77], s[78:79]
    s_branch L_back_5
L_rare_6:
    s_getpc_b64 s[78:79]
L_rarepc_6:
    s_add_u32 s78, s78, L_rescale-L_rarepc_6
    s_addc_u32 s79, s79, 0
    s_swappc_b64 s[76:77], s[78:79]
    s_branch L_back_6
L_rare_7:
    s_getpc_b64 s[78:79]
L_rarepc_7:
    s_add_u32 s78, s78, L_rescale-L_rarepc_7
    s_addc_u32 s79, s79, 0
    s_swappc_b64 s[76:77], s[78:79]
    s_branch L_back_7
L_rare_8:
    s_getpc_b64 s[78:79]
L_rarepc_8:
    s_add_u32 s78, s78, L_rescale-L_rarepc_8
    s_addc_u32 s79, s79, 0
    s_swappc_b64 s[76:77], s[78:79]
    s_branch L_back_8
L_rare_9:
    s_getpc_b64 s[78:79]
L_rarepc_9:
    s_add_u32 s78, s78, L_rescale-L_rarepc_9
    s_addc_u32 s79, s79, 0
    s_swappc_b64 s[76:77], s[78:79]
    s_branch L_back_9
L_rare_10:
    s_getpc_b64 s[78:79]
L_rarepc_10:
    s_add_u32 s78, s78, L_rescale-L_rarepc_10
    s_addc_u32 s79, s79, 0
    s_swappc_b64 s[76:77], s[78:79]
    s_branch L_back_10
L_rare_11:
    s_getpc_b64 s[78:79]
L_rarepc_11:
    s_add_u32 s78, s78, L_rescale-L_rarepc_11
    s_addc_u32 s79, s79, 0
    s_swappc_b64 s[76:77], s[78:79]
    s_branch L_back_11
L_rare_12:
    s_getpc_b64 s[78:79]
L_rarepc_12:
    s_add_u32 s78, s78, L_rescale-L_rarepc_12
    s_addc_u32 s79, s79, 0
    s_swappc_b64 s[76:77], s[78:79]
    s_branch L_back_12
L_rare_13:
    s_getpc_b64 s[78:79]
L_rarepc_13:
    s_add_u32 s78, s78, L_rescale-L_rarepc_13
    s_addc_u32 s79, s79, 0
    s_swappc_b64 s[76:77], s[78:79]
    s_branch L_back_13
L_rare_14:
    s_getpc_b64 s[78:79]
L_rarepc_14:
    s_add_u32 s78, s78, L_rescale-L_rarepc_14
    s_addc_u32 s79, s79, 0
    s_swappc_b64 s[76:77], s[78:79]
    s_branch L_back_14
L_rare_15:
    s_getpc_b64 s[78:79]
L_rarepc_15:
    s_add_u32 s78, s78, L_rescale-L_rarepc_15
    s_addc_u32 s79, s79, 0
    s_swappc_b64 s[76:77], s[78:79]
    s_branch L_back_15
L_rescale:
    s_nop 7
    s_nop 7
    v_mov_b32 v1, v0
    s_nop 1
    v_permlane32_swap_b32 v0, v1
    v_max_f32 v0, v0, v1
    v_ceil_f32 v0, v0
    v_max_f32 v0, 0, v0
    v_sub_f32 v64, v64, v0
    v_sub_f32 v65, v65, v0
    v_sub_f32 v66, v66, v0
    v_sub_f32 v67, v67, v0
    v_sub_f32 v68, v68, v0
    v_sub_f32 v69, v69, v0
    v_sub_f32 v70, v70, v0
    v_sub_f32 v71, v71, v0
    v_sub_f32 v72, v72, v0
    v_sub_f32 v73, v73, v0
    v_sub_f32 v74, v74, v0
    v_sub_f32 v75, v75, v0
    v_sub_f32 v76, v76, v0
    v_sub_f32 v77, v77, v0
    v_sub_f32 v78, v78, v0
    v_sub_f32 v79, v79, v0
    v_sub_f32 v80, v80, v0
    v_sub_f32 v81, v81, v0
    v_sub_f32 v82, v82, v0
    v_sub_f32 v83, v83, v0
    v_sub_f32 v84, v84, v0
    v_sub_f32 v85, v85, v0
    v_sub_f32 v86, v86, v0
    v_sub_f32 v87, v87, v0
    v_sub_f32 v88, v88, v0
    v_sub_f32 v89, v89, v0
    v_sub_f32 v90, v90, v0
    v_sub_f32 v91, v91, v0
    v_sub_f32 v92, v92, v0
    v_sub_f32 v93, v93, v0
    v_sub_f32 v94, v94, v0
    v_sub_f32 v95, v95, v0
    v_sub_f32 v48, v48, v0
    v_sub_f32 v49, v49, v0
    v_sub_f32 v50, v50, v0
    v_sub_f32 v51, v51, v0
    v_sub_f32 v52, v52, v0
    v_sub_f32 v53, v53, v0
    v_sub_f32 v54, v54, v0
    v_sub_f32 v55, v55, v0
    v_sub_f32 v56, v56, v0
    v_sub_f32 v57, v57, v0
    v_sub_f32 v58, v58, v0
    v_sub_f32 v59, v59, v0
    v_sub_f32 v60, v60, v0
    v_sub_f32 v61, v61, v0
    v_sub_f32 v62, v62, v0
    v_sub_f32 v63, v63, v0
    v_sub_f32 v1, 0, v0
    v_exp_f32 v1, v1
    s_nop 0
    v_lshlrev_b32 v2, 16, v128
    v_and_b32 v3, 0xffff0000, v128
    v_mul_f32 v2, v2, v1
    v_mul_f32 v3, v3, v1
    v_cvt_pk_bf16_f32 v128, v2, v3
    v_lshlrev_b32 v2, 16, v129
    v_and_b32 v3, 0xffff0000, v129
    v_mul_f32 v2, v2, v1
    v_mul_f32 v3, v3, v1
    v_cvt_pk_bf16_f32 v129, v2, v3
    v_lshlrev_b32 v2, 16, v130
    v_and_b32 v3, 0xffff0000, v130
    v_mul_f32 v2, v2, v1
    v_mul_f32 v3, v3, v1
    v_cvt_pk_bf16_f32 v130, v2, v3
    v_lshlrev_b32 v2, 16, v131
    v_and_b32 v3, 0xffff0000, v131
    v_mul_f32 v2, v2, v1
    v_mul_f32 v3, v3, v1
    v_cvt_pk_bf16_f32 v131, v2, v3
    v_lshlrev_b32 v2, 16, v132
    v_and_b32 v3, 0xffff0000, v132
    v_mul_f32 v2, v2, v1
    v_mul_f32 v3, v3, v1
    v_cvt_pk_bf16_f32 v132, v2, v3
    v_lshlrev_b32 v2, 16, v133
    v_and_b32 v3, 0xffff0000, v133
    v_mul_f32 v2, v2, v1
    v_mul_f32 v3, v3, v1
    v_cvt_pk_bf16_f32 v133, v2, v3
    v_lshlrev_b32 v2, 16, v134
    v_and_b32 v3, 0xffff0000, v134
    v_mul_f32 v2, v2, v1
    v_mul_f32 v3, v3, v1
    v_cvt_pk_bf16_f32 v134, v2, v3
    v_lshlrev_b32 v2, 16, v135
    v_and_b32 v3, 0xffff0000, v135
    v_mul_f32 v2, v2, v1
    v_mul_f32 v3, v3, v1
    v_cvt_pk_bf16_f32 v135, v2, v3
    v_lshlrev_b32 v2, 16, v136
    v_and_b32 v3, 0xffff0000, v136
    v_mul_f32 v2, v2, v1
    v_mul_f32 v3, v3, v1
    v_cvt_pk_bf16_f32 v136, v2, v3
    v_lshlrev_b32 v2, 16, v137
    v_and_b32 v3, 0xffff0000, v137
    v_mul_f32 v2, v2, v1
    v_mul_f32 v3, v3, v1
    v_cvt_pk_bf16_f32 v137, v2, v3
    v_lshlrev_b32 v2, 16, v138
    v_and_b32 v3, 0xffff0000, v138
    v_mul_f32 v2, v2, v1
    v_mul_f32 v3, v3, v1
    v_cvt_pk_bf16_f32 v138, v2, v3
    v_lshlrev_b32 v2, 16, v139
    v_and_b32 v3, 0xffff0000, v139
    v_mul_f32 v2, v2, v1
    v_mul_f32 v3, v3, v1
    v_cvt_pk_bf16_f32 v139, v2, v3
    v_lshlrev_b32 v2, 16, v140
    v_and_b32 v3, 0xffff0000, v140
    v_mul_f32 v2, v2, v1
    v_mul_f32 v3, v3, v1
    v_cvt_pk_bf16_f32 v140, v2, v3
    v_lshlrev_b32 v2, 16, v141
    v_and_b32 v3, 0xffff0000, v141
    v_mul_f32 v2, v2, v1
    v_mul_f32 v3, v3, v1
    v_cvt_pk_bf16_f32 v141, v2, v3
    v_lshlrev_b32 v2, 16, v142
    v_and_b32 v3, 0xffff0000, v142
    v_mul_f32 v2, v2, v1
    v_mul_f32 v3, v3, v1
    v_cvt_pk_bf16_f32 v142, v2, v3
    v_lshlrev_b32 v2, 16, v143
    v_and_b32 v3, 0xffff0000, v143
    v_mul_f32 v2, v2, v1
    v_mul_f32 v3, v3, v1
    v_cvt_pk_bf16_f32 v143, v2, v3
    v_lshlrev_b32 v2, 16, v144
    v_and_b32 v3, 0xffff0000, v144
    v_mul_f32 v2, v2, v1
    v_mul_f32 v3, v3, v1
    v_cvt_pk_bf16_f32 v144, v2, v3
    v_lshlrev_b32 v2, 16, v145
    v_and_b32 v3, 0xffff0000, v145
    v_mul_f32 v2, v2, v1
    v_mul_f32 v3, v3, v1
    v_cvt_pk_bf16_f32 v145, v2, v3
    v_lshlrev_b32 v2, 16, v146
    v_and_b32 v3, 0xffff0000, v146
    v_mul_f32 v2, v2, v1
    v_mul_f32 v3, v3, v1
    v_cvt_pk_bf16_f32 v146, v2, v3
    v_lshlrev_b32 v2, 16, v147
    v_and_b32 v3, 0xffff0000, v147
    v_mul_f32 v2, v2, v1
    v_mul_f32 v3, v3, v1
    v_cvt_pk_bf16_f32 v147, v2, v3
    v_lshlrev_b32 v2, 16, v148
    v_and_b32 v3, 0xffff0000, v148
    v_mul_f32 v2, v2, v1
    v_mul_f32 v3, v3, v1
    v_cvt_pk_bf16_f32 v148, v2, v3
    v_lshlrev_b32 v2, 16, v149
    v_and_b32 v3, 0xffff0000, v149
    v_mul_f32 v2, v2, v1
    v_mul_f32 v3, v3, v1
    v_cvt_pk_bf16_f32 v149, v2, v3
    v_lshlrev_b32 v2, 16, v150
    v_and_b32 v3, 0xffff0000, v150
    v_mul_f32 v2, v2, v1
    v_mul_f32 v3, v3, v1
    v_cvt_pk_bf16_f32 v150, v2, v3
    v_lshlrev_b32 v2, 16, v151
    v_and_b32 v3, 0xffff0000, v151
    v_mul_f32 v2, v2, v1
    v_mul_f32 v3, v3, v1
    v_cvt_pk_bf16_f32 v151, v2, v3
    v_lshlrev_b32 v2, 16, v152
    v_and_b32 v3, 0xffff0000, v152
    v_mul_f32 v2, v2, v1
    v_mul_f32 v3, v3, v1
    v_cvt_pk_bf16_f32 v152, v2, v3
    v_lshlrev_b32 v2, 16, v153
    v_and_b32 v3, 0xffff0000, v153
    v_mul_f32 v2, v2, v1
    v_mul_f32 v3, v3, v1
    v_cvt_pk_bf16_f32 v153, v2, v3
    v_lshlrev_b32 v2, 16, v154
    v_and_b32 v3, 0xffff0000, v154
    v_mul_f32 v2, v2, v1
    v_mul_f32 v3, v3, v1
    v_cvt_pk_bf16_f32 v154, v2, v3
    v_lshlrev_b32 v2, 16, v155
    v_and_b32 v3, 0xffff0000, v155
    v_mul_f32 v2, v2, v1
    v_mul_f32 v3, v3, v1
    v_cvt_pk_bf16_f32 v155, v2, v3
    v_lshlrev_b32 v2, 16, v156
    v_and_b32 v3, 0xffff0000, v156
    v_mul_f32 v2, v2, v1
    v_mul_f32 v3, v3, v1
    v_cvt_pk_bf16_f32 v156, v2, v3
    v_lshlrev_b32 v2, 16, v157
    v_and_b32 v3, 0xffff0000, v157
    v_mul_f32 v2, v2, v1
    v_mul_f32 v3, v3, v1
    v_cvt_pk_bf16_f32 v157, v2, v3
    v_lshlrev_b32 v2, 16, v158
    v_and_b32 v3, 0xffff0000, v158
    v_mul_f32 v2, v2, v1
    v_mul_f32 v3, v3, v1
    v_cvt_pk_bf16_f32 v158, v2, v3
    v_lshlrev_b32 v2, 16, v159
    v_and_b32 v3, 0xffff0000, v159
    v_mul_f32 v2, v2, v1
    v_mul_f32 v3, v3, v1
    v_cvt_pk_bf16_f32 v159, v2, v3
    v_lshlrev_b32 v2, 16, v160
    v_and_b32 v3, 0xffff0000, v160
    v_mul_f32 v2, v2, v1
    v_mul_f32 v3, v3, v1
    v_cvt_pk_bf16_f32 v160, v2, v3
    v_lshlrev_b32 v2, 16, v161
    v_and_b32 v3, 0xffff0000, v161
    v_mul_f32 v2, v2, v1
    v_mul_f32 v3, v3, v1
    v_cvt_pk_bf16_f32 v161, v2, v3
    v_lshlrev_b32 v2, 16, v162
    v_and_b32 v3, 0xffff0000, v162
    v_mul_f32 v2, v2, v1
    v_mul_f32 v3, v3, v1
    v_cvt_pk_bf16_f32 v162, v2, v3
    v_lshlrev_b32 v2, 16, v163
    v_and_b32 v3, 0xffff0000, v163
    v_mul_f32 v2, v2, v1
    v_mul_f32 v3, v3, v1
    v_cvt_pk_bf16_f32 v163, v2, v3
    v_lshlrev_b32 v2, 16, v164
    v_and_b32 v3, 0xffff0000, v164
    v_mul_f32 v2, v2, v1
    v_mul_f32 v3, v3, v1
    v_cvt_pk_bf16_f32 v164, v2, v3
    v_lshlrev_b32 v2, 16, v165
    v_and_b32 v3, 0xffff0000, v165
    v_mul_f32 v2, v2, v1
    v_mul_f32 v3, v3, v1
    v_cvt_pk_bf16_f32 v165, v2, v3
    v_lshlrev_b32 v2, 16, v166
    v_and_b32 v3, 0xffff0000, v166
    v_mul_f32 v2, v2, v1
    v_mul_f32 v3, v3, v1
    v_cvt_pk_bf16_f32 v166, v2, v3
    v_lshlrev_b32 v2, 16, v167
    v_and_b32 v3, 0xffff0000, v167
    v_mul_f32 v2, v2, v1
    v_mul_f32 v3, v3, v1
    v_cvt_pk_bf16_f32 v167, v2, v3
    v_lshlrev_b32 v2, 16, v168
    v_and_b32 v3, 0xffff0000, v168
    v_mul_f32 v2, v2, v1
    v_mul_f32 v3, v3, v1
    v_cvt_pk_bf16_f32 v168, v2, v3
    v_lshlrev_b32 v2, 16, v169
    v_and_b32 v3, 0xffff0000, v169
    v_mul_f32 v2, v2, v1
    v_mul_f32 v3, v3, v1
    v_cvt_pk_bf16_f32 v169, v2, v3
    v_lshlrev_b32 v2, 16, v170
    v_and_b32 v3, 0xffff0000, v170
    v_mul_f32 v2, v2, v1
    v_mul_f32 v3, v3, v1
    v_cvt_pk_bf16_f32 v170, v2, v3
    v_lshlrev_b32 v2, 16, v171
    v_and_b32 v3, 0xffff0000, v171
    v_mul_f32 v2, v2, v1
    v_mul_f32 v3, v3, v1
    v_cvt_pk_bf16_f32 v171, v2, v3
    v_lshlrev_b32 v2, 16, v172
    v_and_b32 v3, 0xffff0000, v172
    v_mul_f32 v2, v2, v1
    v_mul_f32 v3, v3, v1
    v_cvt_pk_bf16_f32 v172, v2, v3
    v_lshlrev_b32 v2, 16, v173
    v_and_b32 v3, 0xffff0000, v173
    v_mul_f32 v2, v2, v1
    v_mul_f32 v3, v3, v1
    v_cvt_pk_bf16_f32 v173, v2, v3
    v_lshlrev_b32 v2, 16, v174
    v_and_b32 v3, 0xffff0000, v174
    v_mul_f32 v2, v2, v1
    v_mul_f32 v3, v3, v1
    v_cvt_pk_bf16_f32 v174, v2, v3
    v_lshlrev_b32 v2, 16, v175
    v_and_b32 v3, 0xffff0000, v175
    v_mul_f32 v2, v2, v1
    v_mul_f32 v3, v3, v1
    v_cvt_pk_bf16_f32 v175, v2, v3
    v_lshlrev_b32 v2, 16, v176
    v_and_b32 v3, 0xffff0000, v176
    v_mul_f32 v2, v2, v1
    v_mul_f32 v3, v3, v1
    v_cvt_pk_bf16_f32 v176, v2, v3
    v_lshlrev_b32 v2, 16, v177
    v_and_b32 v3, 0xffff0000, v177
    v_mul_f32 v2, v2, v1
    v_mul_f32 v3, v3, v1
    v_cvt_pk_bf16_f32 v177, v2, v3
    v_lshlrev_b32 v2, 16, v178
    v_and_b32 v3, 0xffff0000, v178
    v_mul_f32 v2, v2, v1
    v_mul_f32 v3, v3, v1
    v_cvt_pk_bf16_f32 v178, v2, v3
    v_lshlrev_b32 v2, 16, v179
    v_and_b32 v3, 0xffff0000, v179
    v_mul_f32 v2, v2, v1
    v_mul_f32 v3, v3, v1
    v_cvt_pk_bf16_f32 v179, v2, v3
    v_lshlrev_b32 v2, 16, v180
    v_and_b32 v3, 0xffff0000, v180
    v_mul_f32 v2, v2, v1
    v_mul_f32 v3, v3, v1
    v_cvt_pk_bf16_f32 v180, v2, v3
    v_lshlrev_b32 v2, 16, v181
    v_and_b32 v3, 0xffff0000, v181
    v_mul_f32 v2, v2, v1
    v_mul_f32 v3, v3, v1
    v_cvt_pk_bf16_f32 v181, v2, v3
    v_lshlrev_b32 v2, 16, v182
    v_and_b32 v3, 0xffff0000, v182
    v_mul_f32 v2, v2, v1
    v_mul_f32 v3, v3, v1
    v_cvt_pk_bf16_f32 v182, v2, v3
    v_lshlrev_b32 v2, 16, v183
    v_and_b32 v3, 0xffff0000, v183
    v_mul_f32 v2, v2, v1
    v_mul_f32 v3, v3, v1
    v_cvt_pk_bf16_f32 v183, v2, v3
    v_lshlrev_b32 v2, 16, v184
    v_and_b32 v3, 0xffff0000, v184
    v_mul_f32 v2, v2, v1
    v_mul_f32 v3, v3, v1
    v_cvt_pk_bf16_f32 v184, v2, v3
    v_lshlrev_b32 v2, 16, v185
    v_and_b32 v3, 0xffff0000, v185
    v_mul_f32 v2, v2, v1
    v_mul_f32 v3, v3, v1
    v_cvt_pk_bf16_f32 v185, v2, v3
    v_lshlrev_b32 v2, 16, v186
    v_and_b32 v3, 0xffff0000, v186
    v_mul_f32 v2, v2, v1
    v_mul_f32 v3, v3, v1
    v_cvt_pk_bf16_f32 v186, v2, v3
    v_lshlrev_b32 v2, 16, v187
    v_and_b32 v3, 0xffff0000, v187
    v_mul_f32 v2, v2, v1
    v_mul_f32 v3, v3, v1
    v_cvt_pk_bf16_f32 v187, v2, v3
    v_lshlrev_b32 v2, 16, v188
    v_and_b32 v3, 0xffff0000, v188
    v_mul_f32 v2, v2, v1
    v_mul_f32 v3, v3, v1
    v_cvt_pk_bf16_f32 v188, v2, v3
    v_lshlrev_b32 v2, 16, v189
    v_and_b32 v3, 0xffff0000, v189
    v_mul_f32 v2, v2, v1
    v_mul_f32 v3, v3, v1
    v_cvt_pk_bf16_f32 v189, v2, v3
    v_lshlrev_b32 v2, 16, v190
    v_and_b32 v3, 0xffff0000, v190
    v_mul_f32 v2, v2, v1
    v_mul_f32 v3, v3, v1
    v_cvt_pk_bf16_f32 v190, v2, v3
    v_lshlrev_b32 v2, 16, v191
    v_and_b32 v3, 0xffff0000, v191
    v_mul_f32 v2, v2, v1
    v_mul_f32 v3, v3, v1
    v_cvt_pk_bf16_f32 v191, v2, v3
    v_lshlrev_b32 v2, 16, v192
    v_and_b32 v3, 0xffff0000, v192
    v_mul_f32 v2, v2, v1
    v_mul_f32 v3, v3, v1
    v_cvt_pk_bf16_f32 v192, v2, v3
    v_lshlrev_b32 v2, 16, v193
    v_and_b32 v3, 0xffff0000, v193
    v_mul_f32 v2, v2, v1
    v_mul_f32 v3, v3, v1
    v_cvt_pk_bf16_f32 v193, v2, v3
    v_lshlrev_b32 v2, 16, v194
    v_and_b32 v3, 0xffff0000, v194
    v_mul_f32 v2, v2, v1
    v_mul_f32 v3, v3, v1
    v_cvt_pk_bf16_f32 v194, v2, v3
    v_lshlrev_b32 v2, 16, v195
    v_and_b32 v3, 0xffff0000, v195
    v_mul_f32 v2, v2, v1
    v_mul_f32 v3, v3, v1
    v_cvt_pk_bf16_f32 v195, v2, v3
    v_lshlrev_b32 v2, 16, v196
    v_and_b32 v3, 0xffff0000, v196
    v_mul_f32 v2, v2, v1
    v_mul_f32 v3, v3, v1
    v_cvt_pk_bf16_f32 v196, v2, v3
    v_lshlrev_b32 v2, 16, v197
    v_and_b32 v3, 0xffff0000, v197
    v_mul_f32 v2, v2, v1
    v_mul_f32 v3, v3, v1
    v_cvt_pk_bf16_f32 v197, v2, v3
    v_lshlrev_b32 v2, 16, v198
    v_and_b32 v3, 0xffff0000, v198
    v_mul_f32 v2, v2, v1
    v_mul_f32 v3, v3, v1
    v_cvt_pk_bf16_f32 v198, v2, v3
    v_lshlrev_b32 v2, 16, v199
    v_and_b32 v3, 0xffff0000, v199
    v_mul_f32 v2, v2, v1
    v_mul_f32 v3, v3, v1
    v_cvt_pk_bf16_f32 v199, v2, v3
    v_lshlrev_b32 v2, 16, v200
    v_and_b32 v3, 0xffff0000, v200
    v_mul_f32 v2, v2, v1
    v_mul_f32 v3, v3, v1
    v_cvt_pk_bf16_f32 v200, v2, v3
    v_lshlrev_b32 v2, 16, v201
    v_and_b32 v3, 0xffff0000, v201
    v_mul_f32 v2, v2, v1
    v_mul_f32 v3, v3, v1
    v_cvt_pk_bf16_f32 v201, v2, v3
    v_lshlrev_b32 v2, 16, v202
    v_and_b32 v3, 0xffff0000, v202
    v_mul_f32 v2, v2, v1
    v_mul_f32 v3, v3, v1
    v_cvt_pk_bf16_f32 v202, v2, v3
    v_lshlrev_b32 v2, 16, v203
    v_and_b32 v3, 0xffff0000, v203
    v_mul_f32 v2, v2, v1
    v_mul_f32 v3, v3, v1
    v_cvt_pk_bf16_f32 v203, v2, v3
    v_lshlrev_b32 v2, 16, v204
    v_and_b32 v3, 0xffff0000, v204
    v_mul_f32 v2, v2, v1
    v_mul_f32 v3, v3, v1
    v_cvt_pk_bf16_f32 v204, v2, v3
    v_lshlrev_b32 v2, 16, v205
    v_and_b32 v3, 0xffff0000, v205
    v_mul_f32 v2, v2, v1
    v_mul_f32 v3, v3, v1
    v_cvt_pk_bf16_f32 v205, v2, v3
    v_lshlrev_b32 v2, 16, v206
    v_and_b32 v3, 0xffff0000, v206
    v_mul_f32 v2, v2, v1
    v_mul_f32 v3, v3, v1
    v_cvt_pk_bf16_f32 v206, v2, v3
    v_lshlrev_b32 v2, 16, v207
    v_and_b32 v3, 0xffff0000, v207
    v_mul_f32 v2, v2, v1
    v_mul_f32 v3, v3, v1
    v_cvt_pk_bf16_f32 v207, v2, v3
    v_lshlrev_b32 v2, 16, v208
    v_and_b32 v3, 0xffff0000, v208
    v_mul_f32 v2, v2, v1
    v_mul_f32 v3, v3, v1
    v_cvt_pk_bf16_f32 v208, v2, v3
    v_lshlrev_b32 v2, 16, v209
    v_and_b32 v3, 0xffff0000, v209
    v_mul_f32 v2, v2, v1
    v_mul_f32 v3, v3, v1
    v_cvt_pk_bf16_f32 v209, v2, v3
    v_lshlrev_b32 v2, 16, v210
    v_and_b32 v3, 0xffff0000, v210
    v_mul_f32 v2, v2, v1
    v_mul_f32 v3, v3, v1
    v_cvt_pk_bf16_f32 v210, v2, v3
    v_lshlrev_b32 v2, 16, v211
    v_and_b32 v3, 0xffff0000, v211
    v_mul_f32 v2, v2, v1
    v_mul_f32 v3, v3, v1
    v_cvt_pk_bf16_f32 v211, v2, v3
    v_lshlrev_b32 v2, 16, v212
    v_and_b32 v3, 0xffff0000, v212
    v_mul_f32 v2, v2, v1
    v_mul_f32 v3, v3, v1
    v_cvt_pk_bf16_f32 v212, v2, v3
    v_lshlrev_b32 v2, 16, v213
    v_and_b32 v3, 0xffff0000, v213
    v_mul_f32 v2, v2, v1
    v_mul_f32 v3, v3, v1
    v_cvt_pk_bf16_f32 v213, v2, v3
    v_lshlrev_b32 v2, 16, v214
    v_and_b32 v3, 0xffff0000, v214
    v_mul_f32 v2, v2, v1
    v_mul_f32 v3, v3, v1
    v_cvt_pk_bf16_f32 v214, v2, v3
    v_lshlrev_b32 v2, 16, v215
    v_and_b32 v3, 0xffff0000, v215
    v_mul_f32 v2, v2, v1
    v_mul_f32 v3, v3, v1
    v_cvt_pk_bf16_f32 v215, v2, v3
    v_lshlrev_b32 v2, 16, v216
    v_and_b32 v3, 0xffff0000, v216
    v_mul_f32 v2, v2, v1
    v_mul_f32 v3, v3, v1
    v_cvt_pk_bf16_f32 v216, v2, v3
    v_lshlrev_b32 v2, 16, v217
    v_and_b32 v3, 0xffff0000, v217
    v_mul_f32 v2, v2, v1
    v_mul_f32 v3, v3, v1
    v_cvt_pk_bf16_f32 v217, v2, v3
    v_lshlrev_b32 v2, 16, v218
    v_and_b32 v3, 0xffff0000, v218
    v_mul_f32 v2, v2, v1
    v_mul_f32 v3, v3, v1
    v_cvt_pk_bf16_f32 v218, v2, v3
    v_lshlrev_b32 v2, 16, v219
    v_and_b32 v3, 0xffff0000, v219
    v_mul_f32 v2, v2, v1
    v_mul_f32 v3, v3, v1
    v_cvt_pk_bf16_f32 v219, v2, v3
    v_lshlrev_b32 v2, 16, v220
    v_and_b32 v3, 0xffff0000, v220
    v_mul_f32 v2, v2, v1
    v_mul_f32 v3, v3, v1
    v_cvt_pk_bf16_f32 v220, v2, v3
    v_lshlrev_b32 v2, 16, v221
    v_and_b32 v3, 0xffff0000, v221
    v_mul_f32 v2, v2, v1
    v_mul_f32 v3, v3, v1
    v_cvt_pk_bf16_f32 v221, v2, v3
    v_lshlrev_b32 v2, 16, v222
    v_and_b32 v3, 0xffff0000, v222
    v_mul_f32 v2, v2, v1
    v_mul_f32 v3, v3, v1
    v_cvt_pk_bf16_f32 v222, v2, v3
    v_lshlrev_b32 v2, 16, v223
    v_and_b32 v3, 0xffff0000, v223
    v_mul_f32 v2, v2, v1
    v_mul_f32 v3, v3, v1
    v_cvt_pk_bf16_f32 v223, v2, v3
    v_lshlrev_b32 v2, 16, v224
    v_and_b32 v3, 0xffff0000, v224
    v_mul_f32 v2, v2, v1
    v_mul_f32 v3, v3, v1
    v_cvt_pk_bf16_f32 v224, v2, v3
    v_lshlrev_b32 v2, 16, v225
    v_and_b32 v3, 0xffff0000, v225
    v_mul_f32 v2, v2, v1
    v_mul_f32 v3, v3, v1
    v_cvt_pk_bf16_f32 v225, v2, v3
    v_lshlrev_b32 v2, 16, v226
    v_and_b32 v3, 0xffff0000, v226
    v_mul_f32 v2, v2, v1
    v_mul_f32 v3, v3, v1
    v_cvt_pk_bf16_f32 v226, v2, v3
    v_lshlrev_b32 v2, 16, v227
    v_and_b32 v3, 0xffff0000, v227
    v_mul_f32 v2, v2, v1
    v_mul_f32 v3, v3, v1
    v_cvt_pk_bf16_f32 v227, v2, v3
    v_lshlrev_b32 v2, 16, v228
    v_and_b32 v3, 0xffff0000, v228
    v_mul_f32 v2, v2, v1
    v_mul_f32 v3, v3, v1
    v_cvt_pk_bf16_f32 v228, v2, v3
    v_lshlrev_b32 v2, 16, v229
    v_and_b32 v3, 0xffff0000, v229
    v_mul_f32 v2, v2, v1
    v_mul_f32 v3, v3, v1
    v_cvt_pk_bf16_f32 v229, v2, v3
    v_lshlrev_b32 v2, 16, v230
    v_and_b32 v3, 0xffff0000, v230
    v_mul_f32 v2, v2, v1
    v_mul_f32 v3, v3, v1
    v_cvt_pk_bf16_f32 v230, v2, v3
    v_lshlrev_b32 v2, 16, v231
    v_and_b32 v3, 0xffff0000, v231
    v_mul_f32 v2, v2, v1
    v_mul_f32 v3, v3, v1
    v_cvt_pk_bf16_f32 v231, v2, v3
    v_lshlrev_b32 v2, 16, v232
    v_and_b32 v3, 0xffff0000, v232
    v_mul_f32 v2, v2, v1
    v_mul_f32 v3, v3, v1
    v_cvt_pk_bf16_f32 v232, v2, v3
    v_lshlrev_b32 v2, 16, v233
    v_and_b32 v3, 0xffff0000, v233
    v_mul_f32 v2, v2, v1
    v_mul_f32 v3, v3, v1
    v_cvt_pk_bf16_f32 v233, v2, v3
    v_lshlrev_b32 v2, 16, v234
    v_and_b32 v3, 0xffff0000, v234
    v_mul_f32 v2, v2, v1
    v_mul_f32 v3, v3, v1
    v_cvt_pk_bf16_f32 v234, v2, v3
    v_lshlrev_b32 v2, 16, v235
    v_and_b32 v3, 0xffff0000, v235
    v_mul_f32 v2, v2, v1
    v_mul_f32 v3, v3, v1
    v_cvt_pk_bf16_f32 v235, v2, v3
    v_lshlrev_b32 v2, 16, v236
    v_and_b32 v3, 0xffff0000, v236
    v_mul_f32 v2, v2, v1
    v_mul_f32 v3, v3, v1
    v_cvt_pk_bf16_f32 v236, v2, v3
    v_lshlrev_b32 v2, 16, v237
    v_and_b32 v3, 0xffff0000, v237
    v_mul_f32 v2, v2, v1
    v_mul_f32 v3, v3, v1
    v_cvt_pk_bf16_f32 v237, v2, v3
    v_lshlrev_b32 v2, 16, v238
    v_and_b32 v3, 0xffff0000, v238
    v_mul_f32 v2, v2, v1
    v_mul_f32 v3, v3, v1
    v_cvt_pk_bf16_f32 v238, v2, v3
    v_lshlrev_b32 v2, 16, v239
    v_and_b32 v3, 0xffff0000, v239
    v_mul_f32 v2, v2, v1
    v_mul_f32 v3, v3, v1
    v_cvt_pk_bf16_f32 v239, v2, v3
    v_lshlrev_b32 v2, 16, v240
    v_and_b32 v3, 0xffff0000, v240
    v_mul_f32 v2, v2, v1
    v_mul_f32 v3, v3, v1
    v_cvt_pk_bf16_f32 v240, v2, v3
    v_lshlrev_b32 v2, 16, v241
    v_and_b32 v3, 0xffff0000, v241
    v_mul_f32 v2, v2, v1
    v_mul_f32 v3, v3, v1
    v_cvt_pk_bf16_f32 v241, v2, v3
    v_lshlrev_b32 v2, 16, v242
    v_and_b32 v3, 0xffff0000, v242
    v_mul_f32 v2, v2, v1
    v_mul_f32 v3, v3, v1
    v_cvt_pk_bf16_f32 v242, v2, v3
    v_lshlrev_b32 v2, 16, v243
    v_and_b32 v3, 0xffff0000, v243
    v_mul_f32 v2, v2, v1
    v_mul_f32 v3, v3, v1
    v_cvt_pk_bf16_f32 v243, v2, v3
    v_lshlrev_b32 v2, 16, v244
    v_and_b32 v3, 0xffff0000, v244
    v_mul_f32 v2, v2, v1
    v_mul_f32 v3, v3, v1
    v_cvt_pk_bf16_f32 v244, v2, v3
    v_lshlrev_b32 v2, 16, v245
    v_and_b32 v3, 0xffff0000, v245
    v_mul_f32 v2, v2, v1
    v_mul_f32 v3, v3, v1
    v_cvt_pk_bf16_f32 v245, v2, v3
    v_lshlrev_b32 v2, 16, v246
    v_and_b32 v3, 0xffff0000, v246
    v_mul_f32 v2, v2, v1
    v_mul_f32 v3, v3, v1
    v_cvt_pk_bf16_f32 v246, v2, v3
    v_lshlrev_b32 v2, 16, v247
    v_and_b32 v3, 0xffff0000, v247
    v_mul_f32 v2, v2, v1
    v_mul_f32 v3, v3, v1
    v_cvt_pk_bf16_f32 v247, v2, v3
    v_lshlrev_b32 v2, 16, v248
    v_and_b32 v3, 0xffff0000, v248
    v_mul_f32 v2, v2, v1
    v_mul_f32 v3, v3, v1
    v_cvt_pk_bf16_f32 v248, v2, v3
    v_lshlrev_b32 v2, 16, v249
    v_and_b32 v3, 0xffff0000, v249
    v_mul_f32 v2, v2, v1
    v_mul_f32 v3, v3, v1
    v_cvt_pk_bf16_f32 v249, v2, v3
    v_lshlrev_b32 v2, 16, v250
    v_and_b32 v3, 0xffff0000, v250
    v_mul_f32 v2, v2, v1
    v_mul_f32 v3, v3, v1
    v_cvt_pk_bf16_f32 v250, v2, v3
    v_lshlrev_b32 v2, 16, v251
    v_and_b32 v3, 0xffff0000, v251
    v_mul_f32 v2, v2, v1
    v_mul_f32 v3, v3, v1
    v_cvt_pk_bf16_f32 v251, v2, v3
    v_lshlrev_b32 v2, 16, v252
    v_and_b32 v3, 0xffff0000, v252
    v_mul_f32 v2, v2, v1
    v_mul_f32 v3, v3, v1
    v_cvt_pk_bf16_f32 v252, v2, v3
    v_lshlrev_b32 v2, 16, v253
    v_and_b32 v3, 0xffff0000, v253
    v_mul_f32 v2, v2, v1
    v_mul_f32 v3, v3, v1
    v_cvt_pk_bf16_f32 v253, v2, v3
    v_lshlrev_b32 v2, 16, v254
    v_and_b32 v3, 0xffff0000, v254
    v_mul_f32 v2, v2, v1
    v_mul_f32 v3, v3, v1
    v_cvt_pk_bf16_f32 v254, v2, v3
    v_lshlrev_b32 v2, 16, v255
    v_and_b32 v3, 0xffff0000, v255
    v_mul_f32 v2, v2, v1
    v_mul_f32 v3, v3, v1
    v_cvt_pk_bf16_f32 v255, v2, v3
    s_nop 1
    s_setpc_b64 s[76:77]
L_sp_k0:
    ds_read_b32 v6, v4 offset:0
    s_waitcnt lgkmcnt(0)
    v_cmp_gt_u32 vcc, 1, v6
    s_cbranch_vccz L_ok_k0
    s_cmp_eq_u32 s63, 0
    s_cbranch_scc1 L_ok_k0
    s_sub_u32 s63, s63, 1
    s_sleep 1
    s_branch L_sp_k0
L_sp_k1:
    ds_read_b32 v6, v4 offset:0
    s_waitcnt lgkmcnt(0)
    v_cmp_gt_u32 vcc, 2, v6
    s_cbranch_vccz L_ok_k1
    s_cmp_eq_u32 s63, 0
    s_cbranch_scc1 L_ok_k1
    s_sub_u32 s63, s63, 1
    s_sleep 1
    s_branch L_sp_k1
L_sp_k2:
    ds_read_b32 v6, v4 offset:0
    s_waitcnt lgkmcnt(0)
    v_cmp_gt_u32 vcc, 3, v6
    s_cbranch_vccz L_ok_k2
    s_cmp_eq_u32 s63, 0
    s_cbranch_scc1 L_ok_k2
    s_sub_u32 s63, s63, 1
    s_sleep 1
    s_branch L_sp_k2
L_sp_k3:
    ds_read_b32 v6, v4 offset:0
    s_waitcnt lgkmcnt(0)
    v_cmp_gt_u32 vcc, 4, v6
    s_cbranch_vccz L_ok_k3
    s_cmp_eq_u32 s63, 0
    s_cbranch_scc1 L_ok_k3
    s_sub_u32 s63, s63, 1
    s_sleep 1
    s_branch L_sp_k3
L_sp_k4:
    ds_read_b32 v6, v4 offset:0
    s_waitcnt lgkmcnt(0)
    v_cmp_gt_u32 vcc, 5, v6
    s_cbranch_vccz L_ok_k4
    s_cmp_eq_u32 s63, 0
    s_cbranch_scc1 L_ok_k4
    s_sub_u32 s63, s63, 1
    s_sleep 1
    s_branch L_sp_k4
L_sp_k5:
    ds_read_b32 v6, v4 offset:0
    s_waitcnt lgkmcnt(0)
    v_cmp_gt_u32 vcc, 6, v6
    s_cbranch_vccz L_ok_k5
    s_cmp_eq_u32 s63, 0
    s_cbranch_scc1 L_ok_k5
    s_sub_u32 s63, s63, 1
    s_sleep 1
    s_branch L_sp_k5
L_sp_k6:
    ds_read_b32 v6, v4 offset:0
    s_waitcnt lgkmcnt(0)
    v_cmp_gt_u32 vcc, 7, v6
    s_cbranch_vccz L_ok_k6
    s_cmp_eq_u32 s63, 0
    s_cbranch_scc1 L_ok_k6
    s_sub_u32 s63, s63, 1
    s_sleep 1
    s_branch L_sp_k6
L_sp_k7:
    ds_read_b32 v6, v4 offset:0
    s_waitcnt lgkmcnt(0)
    v_cmp_gt_u32 vcc, 8, v6
    s_cbranch_vccz L_ok_k7
    s_cmp_eq_u32 s63, 0
    s_cbranch_scc1 L_ok_k7
    s_sub_u32 s63, s63, 1
    s_sleep 1
    s_branch L_sp_k7
L_sp_v0:
    ds_read_b32 v6, v4 offset:0
    s_waitcnt lgkmcnt(0)
    v_cmp_gt_u32 vcc, 9, v6
    s_cbranch_vccz L_ok_v0
    s_cmp_eq_u32 s63, 0
    s_cbranch_scc1 L_ok_v0
    s_sub_u32 s63, s63, 1
    s_sleep 1
    s_branch L_sp_v0
L_sp_v1:
    ds_read_b32 v6, v4 offset:0
    s_waitcnt lgkmcnt(0)
    v_cmp_gt_u32 vcc, 10, v6
    s_cbranch_vccz L_ok_v1
    s_cmp_eq_u32 s63, 0
    s_cbranch_scc1 L_ok_v1
    s_sub_u32 s63, s63, 1
    s_sleep 1
    s_branch L_sp_v1
L_sp_v2:
    ds_read_b32 v6, v4 offset:0
    s_waitcnt lgkmcnt(0)
    v_cmp_gt_u32 vcc, 11, v6
    s_cbranch_vccz L_ok_v2
    s_cmp_eq_u32 s63, 0
    s_cbranch_scc1 L_ok_v2
    s_sub_u32 s63, s63, 1
    s_sleep 1
    s_branch L_sp_v2
L_sp_v3:
    ds_read_b32 v6, v4 offset:0
    s_waitcnt lgkmcnt(0)
    v_cmp_gt_u32 vcc, 12, v6
    s_cbranch_vccz L_ok_v3
    s_cmp_eq_u32 s63, 0
    s_cbranch_scc1 L_ok_v3
    s_sub_u32 s63, s63, 1
    s_sleep 1
    s_branch L_sp_v3
L_sp_v4:
    ds_read_b32 v6, v4 offset:0
    s_waitcnt lgkmcnt(0)
    v_cmp_gt_u32 vcc, 13, v6
    s_cbranch_vccz L_ok_v4
    s_cmp_eq_u32 s63, 0
    s_cbranch_scc1 L_ok_v4
    s_sub_u32 s63, s63, 1
    s_sleep 1
    s_branch L_sp_v4
L_sp_o:
    ds_read_b32 v2, v4 offset:16
    s_waitcnt lgkmcnt(0)
    v_cmp_gt_u32 vcc, 11, v2
    s_cbranch_vccz L_ok_o
    s_cmp_eq_u32 s63, 0
    s_cbranch_scc1 L_ok_o
    s_sub_u32 s63, s63, 1
    s_sleep 1
    s_branch L_sp_o
L_sp_v5:
    ds_read_b32 v6, v4 offset:0
    s_waitcnt lgkmcnt(0)
    v_cmp_gt_u32 vcc, 14, v6
    s_cbranch_vccz L_ok_v5
    s_cmp_eq_u32 s63, 0
    s_cbranch_scc1 L_ok_v5
    s_sub_u32 s63, s63, 1
    s_sleep 1
    s_branch L_sp_v5
L_sp_v6:
    ds_read_b32 v6, v4 offset:0
    s_waitcnt lgkmcnt(0)
    v_cmp_gt_u32 vcc, 15, v6
    s_cbranch_vccz L_ok_v6
    s_cmp_eq_u32 s63, 0
    s_cbranch_scc1 L_ok_v6
    s_sub_u32 s63, s63, 1
    s_sleep 1
    s_branch L_sp_v6
L_sp_v7:
    ds_read_b32 v6, v4 offset:0
    s_waitcnt lgkmcnt(0)
    v_cmp_gt_u32 vcc, 16, v6
    s_cbranch_vccz L_ok_v7
    s_cmp_eq_u32 s63, 0
    s_cbranch_scc1 L_ok_v7
    s_sub_u32 s63, s63, 1
    s_sleep 1
    s_branch L_sp_v7
L_B:
    s_sub_u32 s23, s20, 4
    s_lshl_b32 s70, s22, 22
    s_lshl_b32 s71, s21, 19
    s_add_u32 s70, s70, s71
    s_add_u32 s70, s70, 393216
    s_add_u32 s28, s6, s70
    s_addc_u32 s29, s7, 0
    s_mov_b32 s30, 131072
    s_mov_b32 s31, 0x20000
    s_add_u32 s32, s8, s70
    s_addc_u32 s33, s9, 0
    s_mov_b32 s34, 131072
    s_mov_b32 s35, 0x20000
    s_lshl_b32 s66, s23, 10
    v_lshrrev_b32 v11, 4, v0
    v_and_b32 v12, 15, v0
    s_lshl_b32 s72, s23, 2
    v_add_u32 v13, s72, v11
    v_xor_b32 v13, v13, v12
    v_lshlrev_b32 v13, 4, v13
    v_lshl_add_u32 v13, v11, 8, v13
    v_add_u32 v5, s66, v13
    s_cmp_eq_u32 s65, 1
    s_cbranch_scc1 L_B1
L_B2:
    s_add_u32 s36, s12, s71
    s_addc_u32 s37, s13, 0
    s_mov_b32 s38, 524288
    s_mov_b32 s39, 0x20000
    v_lshrrev_b32 v13, 3, v0
    v_bfe_u32 v2, v0, 4, 1
    v_lshlrev_b32 v2, 2, v2
    v_and_b32 v14, 7, v0
    v_xor_b32 v2, v2, v14
    v_lshlrev_b32 v2, 4, v2
    v_lshl_add_u32 v13, v13, 8, v2
    s_lshl_b32 s72, s23, 11
    v_add_u32 v6, s72, v13
    s_cmp_eq_u32 s23, 1
    s_cbranch_scc0 L_notlb2
    s_lshl_b32 s72, s22, 22
    s_lshl_b32 s73, s21, 19
    s_add_u32 s72, s72, s73
    s_add_u32 s72, s72, 393216
    s_load_dword s69, s[6:7], s72
    s_load_dword s69, s[8:9], s72
    s_load_dword s69, s[12:13], s73
    s_lshl_b32 s72, s2, 15
    s_load_dword s69, s[18:19], s72
    s_mov_b32 s73, 8388608
    s_load_dword s69, s[18:19], s73
    s_lshl_b32 s72, s22, 15
    s_load_dword s69, s[14:15], s72
    s_waitcnt lgkmcnt(0)
L_notlb2:
    s_getpc_b64 s[74:75]
L_pc2:
    s_sub_u32 s74, s74, L_pc2-L_start
    s_subb_u32 s75, s75, 0
    s_lshl_b32 s72, s22, 2
    s_add_u32 s72, s72, s23
    v_and_b32 v2, 3, v0
    v_lshl_add_u32 v2, s72, 2, v2
    v_lshlrev_b32 v2, 7, v2
    v_min_u32 v2, L_code_end-L_start-4, v2
    global_load_dword v251, v2, s[74:75]
    s_lshl_b32 s72, s2, 15
    s_add_u32 s40, s18, s72
    s_addc_u32 s41, s19, 0
    s_mov_b32 s42, 32768
    s_mov_b32 s43, 0x20000
    s_add_u32 s48, s18, 8388608
    s_addc_u32 s49, s19, 0
    s_mov_b32 s50, 16384
    s_mov_b32 s51, 0x20000
    s_mov_b32 s52, s14
    s_mov_b32 s53, s15
    s_mov_b32 s54, 1048576
    s_mov_b32 s55, 0x20000
    v_lshlrev_b32 v3, 13, v11
    v_lshl_add_u32 v3, v12, 4, v3
    s_lshl_b32 s72, s23, 8
    v_add_u32 v3, s72, v3
    v_add_u32 v4, 4096, v3
    v_xor_b32 v9, v12, v11
    v_lshlrev_b32 v9, 4, v9
    v_lshl_add_u32 v9, v12, 10, v9
    v_add_u32 v9, 131072, v9
    v_and_b32 v7, 3, v0
    v_lshlrev_b32 v7, 2, v7
    v_add_u32 v7, 114688, v7
    s_lshl_b32 s72, s23, 2
    s_add_u32 s72, s72, 114688
    v_mov_b32 v8, s72
    v_mov_b32 v16, 0
    v_mov_b32 v17, 0
    v_mov_b32 v18, 0
    v_mov_b32 v19, 0
    v_mov_b32 v20, 0
    v_mov_b32 v21, 0
    v_mov_b32 v22, 0
    v_mov_b32 v23, 0
    v_mov_b32 v24, 0
    v_mov_b32 v25, 0
    v_mov_b32 v26, 0
    v_mov_b32 v27, 0
    v_mov_b32 v28, 0
    v_mov_b32 v29, 0
    v_mov_b32 v30, 0
    v_mov_b32 v31, 0
    v_mov_b32 v32, 0
    v_mov_b32 v33, 0
    v_mov_b32 v34, 0
    v_mov_b32 v35, 0
    v_mov_b32 v36, 0
    v_mov_b32 v37, 0
    v_mov_b32 v38, 0
    v_mov_b32 v39, 0
    v_mov_b32 v40, 0
    v_mov_b32 v41, 0
    v_mov_b32 v42, 0
    v_mov_b32 v43, 0
    v_mov_b32 v44, 0
    v_mov_b32 v45, 0
    v_mov_b32 v46, 0
    v_mov_b32 v47, 0
    v_mov_b32 v48, 0
    v_mov_b32 v49, 0
    v_mov_b32 v50, 0
    v_mov_b32 v51, 0
    v_mov_b32 v52, 0
    v_mov_b32 v53, 0
    v_mov_b32 v54, 0
    v_mov_b32 v55, 0
    v_mov_b32 v56, 0
    v_mov_b32 v57, 0
    v_mov_b32 v58, 0
    v_mov_b32 v59, 0
    v_mov_b32 v60, 0
    v_mov_b32 v61, 0
    v_mov_b32 v62, 0
    v_mov_b32 v63, 0
    v_mov_b32 v64, 0
    v_mov_b32 v65, 0
    v_mov_b32 v66, 0
    v_mov_b32 v67, 0
    v_mov_b32 v68, 0
    v_mov_b32 v69, 0
    v_mov_b32 v70, 0
    v_mov_b32 v71, 0
    v_mov_b32 v72, 0
    v_mov_b32 v73, 0
    v_mov_b32 v74, 0
    v_mov_b32 v75, 0
    v_mov_b32 v76, 0
    v_mov_b32 v77, 0
    v_mov_b32 v78, 0
    v_mov_b32 v79, 0
    s_cmp_eq_u32 s23, 0
    s_cbranch_scc0 L_b2_noclr
    s_add_u32 s48, s18, 8388608
    s_addc_u32 s49, s19, 0
    s_mov_b32 s50, 16384
    s_mov_b32 s51, 0x20000
    s_lshl_b32 s74, s22, 9
    s_lshl_b32 s75, s21, 2
    s_add_u32 s74, s74, s75
    v_lshlrev_b32 v14, 7, v0
    v_mov_b32 v15, 0
    v_cmp_gt_u32 vcc, 4, v0
    s_and_saveexec_b64 s[72:73], vcc
    buffer_store_dword v15, v14, s[48:51], s74 offen sc1
    s_mov_b64 exec, s[72:73]
    s_waitcnt vmcnt(0)
    s_lshl_b32 s74, s22, 2
    v_mov_b32 v14, s74
    v_mov_b32 v15, 1
    v_cmp_eq_u32 vcc, 0, v0
    s_and_saveexec_b64 s[72:73], vcc
    global_atomic_add v14, v15, s[16:17] sc1
    s_mov_b64 exec, s[72:73]
L_b2_noclr:
    s_barrier
L_g2_1:
    ds_read_b32 v14, v7 offset:16
    s_waitcnt lgkmcnt(0)
    v_cmp_gt_u32 vcc, 1, v14
    s_cbranch_vccz L_g2_1_ok
    s_cmp_eq_u32 s63, 0
    s_cbranch_scc1 L_g2_1_ok
    s_sub_u32 s63, s63, 1
    s_sleep 2
    s_branch L_g2_1
L_g2_1_ok:
    s_add_u32 m0, s66, 0
    s_mov_b32 s70, 0
    buffer_load_dwordx4 v5, s[28:31], s70 offen nt lds
    s_add_u32 m0, s66, 4096
    s_mov_b32 s70, 4096
    buffer_load_dwordx4 v5, s[28:31], s70 offen nt lds
    s_add_u32 m0, s66, 8192
    s_mov_b32 s70, 8192
    buffer_load_dwordx4 v5, s[28:31], s70 offen nt lds
    s_add_u32 m0, s66, 12288
    s_mov_b32 s70, 12288
    buffer_load_dwordx4 v5, s[28:31], s70 offen nt lds
    s_add_u32 m0, s66, 16384
    s_mov_b32 s70, 16384
    buffer_load_dwordx4 v5, s[28:31], s70 offen nt lds
    s_add_u32 m0, s66, 20480
    s_mov_b32 s70, 20480
    buffer_load_dwordx4 v5, s[28:31], s70 offen nt lds
    s_add_u32 m0, s66, 24576
    s_mov_b32 s70, 24576
    buffer_load_dwordx4 v5, s[28:31], s70 offen nt lds
    s_add_u32 m0, s66, 28672
    s_mov_b32 s70, 28672
    buffer_load_dwordx4 v5, s[28:31], s70 offen nt lds
    s_add_u32 m0, s66, 32768
    s_mov_b32 s70, 32768
    buffer_load_dwordx4 v5, s[28:31], s70 offen nt lds
    s_add_u32 m0, s66, 36864
    s_mov_b32 s70, 36864
    buffer_load_dwordx4 v5, s[28:31], s70 offen nt lds
    s_add_u32 m0, s66, 40960
    s_mov_b32 s70, 40960
    buffer_load_dwordx4 v5, s[28:31], s70 offen nt lds
    s_add_u32 m0, s66, 45056
    s_mov_b32 s70, 45056
    buffer_load_dwordx4 v5, s[28:31], s70 offen nt lds
    s_add_u32 m0, s66, 49152
    s_mov_b32 s70, 49152
    buffer_load_dwordx4 v5, s[28:31], s70 offen nt lds
    s_add_u32 m0, s66, 53248
    s_mov_b32 s70, 53248
    buffer_load_dwordx4 v5, s[28:31], s70 offen nt lds
    s_add_u32 m0, s66, 57344
    s_mov_b32 s70, 57344
    buffer_load_dwordx4 v5, s[28:31], s70 offen nt lds
    s_add_u32 m0, s66, 61440
    s_mov_b32 s70, 61440
    buffer_load_dwordx4 v5, s[28:31], s70 offen nt lds
    s_add_u32 m0, s66, 65536
    s_mov_b32 s70, 65536
    buffer_load_dwordx4 v5, s[28:31], s70 offen nt lds
    s_add_u32 m0, s66, 69632
    s_mov_b32 s70, 69632
    buffer_load_dwordx4 v5, s[28:31], s70 offen nt lds
    s_add_u32 m0, s66, 73728
    s_mov_b32 s70, 73728
    buffer_load_dwordx4 v5, s[28:31], s70 offen nt lds
    s_add_u32 m0, s66, 77824
    s_mov_b32 s70, 77824
    buffer_load_dwordx4 v5, s[28:31], s70 offen nt lds
    s_waitcnt vmcnt(16)
    v_mov_b32 v14, 1
    ds_write_b32 v8, v14
    s_add_u32 m0, s66, 81920
    s_mov_b32 s70, 81920
    buffer_load_dwordx4 v5, s[28:31], s70 offen nt lds
    s_add_u32 m0, s66, 86016
    s_mov_b32 s70, 86016
    buffer_load_dwordx4 v5, s[28:31], s70 offen nt lds
    s_add_u32 m0, s66, 90112
    s_mov_b32 s70, 90112
    buffer_load_dwordx4 v5, s[28:31], s70 offen nt lds
    s_add_u32 m0, s66, 94208
    s_mov_b32 s70, 94208
    buffer_load_dwordx4 v5, s[28:31], s70 offen nt lds
    s_waitcnt vmcnt(16)
    v_mov_b32 v14, 2
    ds_write_b32 v8, v14
    s_add_u32 m0, s66, 98304
    s_mov_b32 s70, 98304
    buffer_load_dwordx4 v5, s[28:31], s70 offen nt lds
    s_add_u32 m0, s66, 102400
    s_mov_b32 s70, 102400
    buffer_load_dwordx4 v5, s[28:31], s70 offen nt lds
    s_add_u32 m0, s66, 106496
    s_mov_b32 s70, 106496
    buffer_load_dwordx4 v5, s[28:31], s70 offen nt lds
    s_add_u32 m0, s66, 110592
    s_mov_b32 s70, 110592
    buffer_load_dwordx4 v5, s[28:31], s70 offen nt lds
    s_waitcnt vmcnt(16)
    v_mov_b32 v14, 3
    ds_write_b32 v8, v14
L_g2_2:
    ds_read_b32 v14, v7 offset:16
    s_waitcnt lgkmcnt(0)
    v_cmp_gt_u32 vcc, 2, v14
    s_cbranch_vccz L_g2_2_ok
    s_cmp_eq_u32 s63, 0
    s_cbranch_scc1 L_g2_2_ok
    s_sub_u32 s63, s63, 1
    s_sleep 2
    s_branch L_g2_2
L_g2_2_ok:
    s_add_u32 m0, s66, 131072
    s_mov_b32 s70, 114688
    buffer_load_dwordx4 v5, s[28:31], s70 offen nt lds
    s_add_u32 m0, s66, 135168
    s_mov_b32 s70, 118784
    buffer_load_dwordx4 v5, s[28:31], s70 offen nt lds
    s_add_u32 m0, s66, 139264
    s_mov_b32 s70, 122880
    buffer_load_dwordx4 v5, s[28:31], s70 offen nt lds
    s_add_u32 m0, s66, 143360
    s_mov_b32 s70, 126976
    buffer_load_dwordx4 v5, s[28:31], s70 offen nt lds
    s_waitcnt vmcnt(16)
    v_mov_b32 v14, 4
    ds_write_b32 v8, v14
    s_add_u32 m0, s66, 147456
    s_mov_b32 s70, 0
    buffer_load_dwordx4 v6, s[32:35], s70 offen nt lds
    s_add_u32 m0, s66, 151552
    s_mov_b32 s70, 8192
    buffer_load_dwordx4 v6, s[32:35], s70 offen nt lds
    s_add_u32 m0, s66, 155648
    s_mov_b32 s70, 16384
    buffer_load_dwordx4 v6, s[32:35], s70 offen nt lds
    s_add_u32 m0, s66, 159744
    s_mov_b32 s70, 24576
    buffer_load_dwordx4 v6, s[32:35], s70 offen nt lds
    s_waitcnt vmcnt(16)
    v_mov_b32 v14, 5
    ds_write_b32 v8, v14
L_g2_3:
    ds_read_b32 v14, v7 offset:16
    s_waitcnt lgkmcnt(0)
    v_cmp_gt_u32 vcc, 3, v14
    s_cbranch_vccz L_g2_3_ok
    s_cmp_eq_u32 s63, 0
    s_cbranch_scc1 L_g2_3_ok
    s_sub_u32 s63, s63, 1
    s_sleep 2
    s_branch L_g2_3
L_g2_3_ok:
    s_add_u32 m0, s66, 0
    s_mov_b32 s70, 32768
    buffer_load_dwordx4 v6, s[32:35], s70 offen nt lds
    s_add_u32 m0, s66, 4096
    s_mov_b32 s70, 40960
    buffer_load_dwordx4 v6, s[32:35], s70 offen nt lds
    s_add_u32 m0, s66, 8192
    s_mov_b32 s70, 49152
    buffer_load_dwordx4 v6, s[32:35], s70 offen nt lds
    s_add_u32 m0, s66, 12288
    s_mov_b32 s70, 57344
    buffer_load_dwordx4 v6, s[32:35], s70 offen nt lds
    s_waitcnt vmcnt(16)
    v_mov_b32 v14, 6
    ds_write_b32 v8, v14
L_g2_4:
    ds_read_b32 v14, v7 offset:16
    s_waitcnt lgkmcnt(0)
    v_cmp_gt_u32 vcc, 4, v14
    s_cbranch_vccz L_g2_4_ok
    s_cmp_eq_u32 s63, 0
    s_cbranch_scc1 L_g2_4_ok
    s_sub_u32 s63, s63, 1
    s_sleep 2
    s_branch L_g2_4
L_g2_4_ok:
    s_add_u32 m0, s66, 16384
    s_mov_b32 s70, 65536
    buffer_load_dwordx4 v6, s[32:35], s70 offen nt lds
    s_add_u32 m0, s66, 20480
    s_mov_b32 s70, 73728
    buffer_load_dwordx4 v6, s[32:35], s70 offen nt lds
    s_add_u32 m0, s66, 24576
    s_mov_b32 s70, 81920
    buffer_load_dwordx4 v6, s[32:35], s70 offen nt lds
    s_add_u32 m0, s66, 28672
    s_mov_b32 s70, 90112
    buffer_load_dwordx4 v6, s[32:35], s70 offen nt lds
    s_waitcnt vmcnt(16)
    v_mov_b32 v14, 7
    ds_write_b32 v8, v14
L_g2_5:
    ds_read_b32 v14, v7 offset:16
    s_waitcnt lgkmcnt(0)
    v_cmp_gt_u32 vcc, 5, v14
    s_cbranch_vccz L_g2_5_ok
    s_cmp_eq_u32 s63, 0
    s_cbranch_scc1 L_g2_5_ok
    s_sub_u32 s63, s63, 1
    s_sleep 2
    s_branch L_g2_5
L_g2_5_ok:
    s_add_u32 m0, s66, 32768
    s_mov_b32 s70, 98304
    buffer_load_dwordx4 v6, s[32:35], s70 offen nt lds
    s_add_u32 m0, s66, 36864
    s_mov_b32 s70, 106496
    buffer_load_dwordx4 v6, s[32:35], s70 offen nt lds
    s_add_u32 m0, s66, 40960
    s_mov_b32 s70, 114688
    buffer_load_dwordx4 v6, s[32:35], s70 offen nt lds
    s_add_u32 m0, s66, 45056
    s_mov_b32 s70, 122880
    buffer_load_dwordx4 v6, s[32:35], s70 offen nt lds
    s_waitcnt vmcnt(16)
    v_mov_b32 v14, 8
    ds_write_b32 v8, v14
    s_add_u32 s60, s58, s59
    s_and_b32 s69, s60, 6
    s_and_b32 s60, s60, 1
    s_lshl_b32 s69, s69, 1
    s_or_b32 s60, s60, s69
    s_and_b32 s69, s59, 8
    s_lshr_b32 s69, s69, 2
    s_or_b32 s60, s60, s69
    s_lshl_b32 s60, s60, 15
    s_add_u32 s59, s59, 1
    buffer_load_dwordx4 v[80:83], v3, s[36:39], s60 offen offset:0
    buffer_load_dwordx4 v[84:87], v3, s[36:39], s60 offen offset:1024
    buffer_load_dwordx4 v[88:91], v3, s[36:39], s60 offen offset:2048
    buffer_load_dwordx4 v[92:95], v3, s[36:39], s60 offen offset:3072
    buffer_load_dwordx4 v[96:99], v4, s[36:39], s60 offen offset:0
    buffer_load_dwordx4 v[100:103], v4, s[36:39], s60 offen offset:1024
    buffer_load_dwordx4 v[104:107], v4, s[36:39], s60 offen offset:2048
    buffer_load_dwordx4 v[108:111], v4, s[36:39], s60 offen offset:3072
    s_waitcnt vmcnt(20)
    v_mov_b32 v14, 9
    ds_write_b32 v8, v14
    s_add_u32 s60, s58, s59
    s_and_b32 s69, s60, 6
    s_and_b32 s60, s60, 1
    s_lshl_b32 s69, s69, 1
    s_or_b32 s60, s60, s69
    s_and_b32 s69, s59, 8
    s_lshr_b32 s69, s69, 2
    s_or_b32 s60, s60, s69
    s_lshl_b32 s60, s60, 15
    s_add_u32 s59, s59, 1
    buffer_load_dwordx4 v[112:115], v3, s[36:39], s60 offen offset:0
    buffer_load_dwordx4 v[116:119], v3, s[36:39], s60 offen offset:1024
    buffer_load_dwordx4 v[120:123], v3, s[36:39], s60 offen offset:2048
    buffer_load_dwordx4 v[124:127], v3, s[36:39], s60 offen offset:3072
    buffer_load_dwordx4 v[128:131], v4, s[36:39], s60 offen offset:0
    buffer_load_dwordx4 v[132:135], v4, s[36:39], s60 offen offset:1024
    buffer_load_dwordx4 v[136:139], v4, s[36:39], s60 offen offset:2048
    buffer_load_dwordx4 v[140:143], v4, s[36:39], s60 offen offset:3072
    s_waitcnt vmcnt(24)
    v_mov_b32 v14, 10
    ds_write_b32 v8, v14
    s_add_u32 s60, s58, s59
    s_and_b32 s69, s60, 6
    s_and_b32 s60, s60, 1
    s_lshl_b32 s69, s69, 1
    s_or_b32 s60, s60, s69
    s_and_b32 s69, s59, 8
    s_lshr_b32 s69, s69, 2
    s_or_b32 s60, s60, s69
    s_lshl_b32 s60, s60, 15
    s_add_u32 s59, s59, 1
    buffer_load_dwordx4 v[144:147], v3, s[36:39], s60 offen offset:0
    buffer_load_dwordx4 v[148:151], v3, s[36:39], s60 offen offset:1024
    buffer_load_dwordx4 v[152:155], v3, s[36:39], s60 offen offset:2048
    buffer_load_dwordx4 v[156:159], v3, s[36:39], s60 offen offset:3072
    buffer_load_dwordx4 v[160:163], v4, s[36:39], s60 offen offset:0
    buffer_load_dwordx4 v[164:167], v4, s[36:39], s60 offen offset:1024
    buffer_load_dwordx4 v[168:171], v4, s[36:39], s60 offen offset:2048
    buffer_load_dwordx4 v[172:175], v4, s[36:39], s60 offen offset:3072
    s_waitcnt vmcnt(28)
    v_mov_b32 v14, 11
    ds_write_b32 v8, v14
L_g2_6:
    ds_read_b32 v14, v7 offset:16
    s_waitcnt lgkmcnt(0)
    v_cmp_gt_u32 vcc, 6, v14
    s_cbranch_vccz L_g2_6_ok
    s_cmp_eq_u32 s63, 0
    s_cbranch_scc1 L_g2_6_ok
    s_sub_u32 s63, s63, 1
    s_sleep 2
    s_branch L_g2_6
L_g2_6_ok:
    s_add_u32 m0, s66, 49152
    s_mov_b32 s70, 128
    buffer_load_dwordx4 v6, s[32:35], s70 offen nt lds
    s_add_u32 m0, s66, 53248
    s_mov_b32 s70, 8320
    buffer_load_dwordx4 v6, s[32:35], s70 offen nt lds
    s_add_u32 m0, s66, 57344
    s_mov_b32 s70, 16512
    buffer_load_dwordx4 v6, s[32:35], s70 offen nt lds
    s_add_u32 m0, s66, 61440
    s_mov_b32 s70, 24704
    buffer_load_dwordx4 v6, s[32:35], s70 offen nt lds
    s_waitcnt vmcnt(28)
    v_mov_b32 v14, 12
    ds_write_b32 v8, v14
L_g2_7:
    ds_read_b32 v14, v7 offset:16
    s_waitcnt lgkmcnt(0)
    v_cmp_gt_u32 vcc, 7, v14
    s_cbranch_vccz L_g2_7_ok
    s_cmp_eq_u32 s63, 0
    s_cbranch_scc1 L_g2_7_ok
    s_sub_u32 s63, s63, 1
    s_sleep 2
    s_branch L_g2_7
L_g2_7_ok:
    s_add_u32 m0, s66, 65536
    s_mov_b32 s70, 32896
    buffer_load_dwordx4 v6, s[32:35], s70 offen nt lds
    s_add_u32 m0, s66, 69632
    s_mov_b32 s70, 41088
    buffer_load_dwordx4 v6, s[32:35], s70 offen nt lds
    s_add_u32 m0, s66, 73728
    s_mov_b32 s70, 49280
    buffer_load_dwordx4 v6, s[32:35], s70 offen nt lds
    s_add_u32 m0, s66, 77824
    s_mov_b32 s70, 57472
    buffer_load_dwordx4 v6, s[32:35], s70 offen nt lds
L_g2_8:
    ds_read_b32 v14, v7 offset:16
    s_waitcnt lgkmcnt(0)
    v_cmp_gt_u32 vcc, 8, v14
    s_cbranch_vccz L_g2_8_ok
    s_cmp_eq_u32 s63, 0
    s_cbranch_scc1 L_g2_8_ok
    s_sub_u32 s63, s63, 1
    s_sleep 2
    s_branch L_g2_8
L_g2_8_ok:
    s_add_u32 m0, s66, 81920
    s_mov_b32 s70, 65664
    buffer_load_dwordx4 v6, s[32:35], s70 offen nt lds
    s_add_u32 m0, s66, 86016
    s_mov_b32 s70, 73856
    buffer_load_dwordx4 v6, s[32:35], s70 offen nt lds
    s_add_u32 m0, s66, 90112
    s_mov_b32 s70, 82048
    buffer_load_dwordx4 v6, s[32:35], s70 offen nt lds
    s_add_u32 m0, s66, 94208
    s_mov_b32 s70, 90240
    buffer_load_dwordx4 v6, s[32:35], s70 offen nt lds
L_g2_9:
    ds_read_b32 v14, v7 offset:16
    s_waitcnt lgkmcnt(0)
    v_cmp_gt_u32 vcc, 9, v14
    s_cbranch_vccz L_g2_9_ok
    s_cmp_eq_u32 s63, 0
    s_cbranch_scc1 L_g2_9_ok
    s_sub_u32 s63, s63, 1
    s_sleep 2
    s_branch L_g2_9
L_g2_9_ok:
    s_add_u32 m0, s66, 98304
    s_mov_b32 s70, 98432
    buffer_load_dwordx4 v6, s[32:35], s70 offen nt lds
    s_add_u32 m0, s66, 102400
    s_mov_b32 s70, 106624
    buffer_load_dwordx4 v6, s[32:35], s70 offen nt lds
    s_add_u32 m0, s66, 106496
    s_mov_b32 s70, 114816
    buffer_load_dwordx4 v6, s[32:35], s70 offen nt lds
    s_add_u32 m0, s66, 110592
    s_mov_b32 s70, 123008
    buffer_load_dwordx4 v6, s[32:35], s70 offen nt lds
    s_waitcnt vmcnt(12)
    v_mov_b32 v14, 13
    ds_write_b32 v8, v14
    s_waitcnt vmcnt(8)
    v_mov_b32 v14, 14
    ds_write_b32 v8, v14
    s_waitcnt vmcnt(4)
    v_mov_b32 v14, 15
    ds_write_b32 v8, v14
    s_waitcnt vmcnt(0)
    v_mov_b32 v14, 16
    ds_write_b32 v8, v14
    s_lshl_b32 s70, s22, 2
    v_mov_b32 v241, s70
    s_branch L_outproj
L_B1:
    s_cmp_eq_u32 s23, 0
    s_cbranch_scc0 L_b1_noclr
    s_add_u32 s48, s18, 8388608
    s_addc_u32 s49, s19, 0
    s_mov_b32 s50, 16384
    s_mov_b32 s51, 0x20000
    s_lshl_b32 s74, s22, 9
    s_lshl_b32 s75, s21, 2
    s_add_u32 s74, s74, s75
    v_lshlrev_b32 v14, 7, v0
    v_mov_b32 v15, 0
    v_cmp_gt_u32 vcc, 4, v0
    s_and_saveexec_b64 s[72:73], vcc
    buffer_store_dword v15, v14, s[48:51], s74 offen sc1
    s_mov_b64 exec, s[72:73]
L_b1_noclr:
    s_add_u32 m0, s66, 0
    s_mov_b32 s70, 0
    buffer_load_dwordx4 v5, s[28:31], s70 offen nt lds
    s_add_u32 m0, s66, 4096
    s_mov_b32 s70, 4096
    buffer_load_dwordx4 v5, s[28:31], s70 offen nt lds
    s_add_u32 m0, s66, 8192
    s_mov_b32 s70, 8192
    buffer_load_dwordx4 v5, s[28:31], s70 offen nt lds
    s_add_u32 m0, s66, 12288
    s_mov_b32 s70, 12288
    buffer_load_dwordx4 v5, s[28:31], s70 offen nt lds
    s_add_u32 m0, s66, 16384
    s_mov_b32 s70, 16384
    buffer_load_dwordx4 v5, s[28:31], s70 offen nt lds
    s_add_u32 m0, s66, 20480
    s_mov_b32 s70, 20480
    buffer_load_dwordx4 v5, s[28:31], s70 offen nt lds
    s_add_u32 m0, s66, 24576
    s_mov_b32 s70, 24576
    buffer_load_dwordx4 v5, s[28:31], s70 offen nt lds
    s_add_u32 m0, s66, 28672
    s_mov_b32 s70, 28672
    buffer_load_dwordx4 v5, s[28:31], s70 offen nt lds
    s_add_u32 m0, s66, 32768
    s_mov_b32 s70, 32768
    buffer_load_dwordx4 v5, s[28:31], s70 offen nt lds
    s_add_u32 m0, s66, 36864
    s_mov_b32 s70, 36864
    buffer_load_dwordx4 v5, s[28:31], s70 offen nt lds
    s_add_u32 m0, s66, 40960
    s_mov_b32 s70, 40960
    buffer_load_dwordx4 v5, s[28:31], s70 offen nt lds
    s_add_u32 m0, s66, 45056
    s_mov_b32 s70, 45056
    buffer_load_dwordx4 v5, s[28:31], s70 offen nt lds
    s_add_u32 m0, s66, 49152
    s_mov_b32 s70, 49152
    buffer_load_dwordx4 v5, s[28:31], s70 offen nt lds
    s_add_u32 m0, s66, 53248
    s_mov_b32 s70, 53248
    buffer_load_dwordx4 v5, s[28:31], s70 offen nt lds
    s_add_u32 m0, s66, 57344
    s_mov_b32 s70, 57344
    buffer_load_dwordx4 v5, s[28:31], s70 offen nt lds
    s_add_u32 m0, s66, 61440
    s_mov_b32 s70, 61440
    buffer_load_dwordx4 v5, s[28:31], s70 offen nt lds
    s_add_u32 m0, s66, 65536
    s_mov_b32 s70, 65536
    buffer_load_dwordx4 v5, s[28:31], s70 offen nt lds
    s_add_u32 m0, s66, 69632
    s_mov_b32 s70, 69632
    buffer_load_dwordx4 v5, s[28:31], s70 offen nt lds
    s_add_u32 m0, s66, 73728
    s_mov_b32 s70, 73728
    buffer_load_dwordx4 v5, s[28:31], s70 offen nt lds
    s_add_u32 m0, s66, 77824
    s_mov_b32 s70, 77824
    buffer_load_dwordx4 v5, s[28:31], s70 offen nt lds
    s_add_u32 m0, s66, 81920
    s_mov_b32 s70, 81920
    buffer_load_dwordx4 v5, s[28:31], s70 offen nt lds
    s_add_u32 m0, s66, 86016
    s_mov_b32 s70, 86016
    buffer_load_dwordx4 v5, s[28:31], s70 offen nt lds
    s_add_u32 m0, s66, 90112
    s_mov_b32 s70, 90112
    buffer_load_dwordx4 v5, s[28:31], s70 offen nt lds
    s_add_u32 m0, s66, 94208
    s_mov_b32 s70, 94208
    buffer_load_dwordx4 v5, s[28:31], s70 offen nt lds
    s_add_u32 m0, s66, 98304
    s_mov_b32 s70, 98304
    buffer_load_dwordx4 v5, s[28:31], s70 offen nt lds
    s_add_u32 m0, s66, 102400
    s_mov_b32 s70, 102400
    buffer_load_dwordx4 v5, s[28:31], s70 offen nt lds
    s_add_u32 m0, s66, 106496
    s_mov_b32 s70, 106496
    buffer_load_dwordx4 v5, s[28:31], s70 offen nt lds
    s_add_u32 m0, s66, 110592
    s_mov_b32 s70, 110592
    buffer_load_dwordx4 v5, s[28:31], s70 offen nt lds
    s_add_u32 s36, s12, s71
    s_addc_u32 s37, s13, 0
    s_mov_b32 s38, 524288
    s_mov_b32 s39, 0x20000
    v_lshrrev_b32 v13, 3, v0
    v_bfe_u32 v2, v0, 4, 1
    v_lshlrev_b32 v2, 2, v2
    v_and_b32 v14, 7, v0
    v_xor_b32 v2, v2, v14
    v_lshlrev_b32 v2, 4, v2
    v_lshl_add_u32 v13, v13, 8, v2
    s_lshl_b32 s72, s23, 11
    v_add_u32 v6, s72, v13
    s_cmp_eq_u32 s23, 1
    s_cbranch_scc0 L_notlb1
    s_lshl_b32 s72, s22, 22
    s_lshl_b32 s73, s21, 19
    s_add_u32 s72, s72, s73
    s_add_u32 s72, s72, 393216
    s_load_dword s69, s[6:7], s72
    s_load_dword s69, s[8:9], s72
    s_load_dword s69, s[12:13], s73
    s_lshl_b32 s72, s2, 15
    s_load_dword s69, s[18:19], s72
    s_mov_b32 s73, 8388608
    s_load_dword s69, s[18:19], s73
    s_lshl_b32 s72, s22, 15
    s_load_dword s69, s[14:15], s72
    s_waitcnt lgkmcnt(0)
L_notlb1:
    s_getpc_b64 s[74:75]
L_pc1:
    s_sub_u32 s74, s74, L_pc1-L_start
    s_subb_u32 s75, s75, 0
    s_lshl_b32 s72, s22, 2
    s_add_u32 s72, s72, s23
    v_and_b32 v2, 3, v0
    v_lshl_add_u32 v2, s72, 2, v2
    v_lshlrev_b32 v2, 7, v2
    v_min_u32 v2, L_code_end-L_start-4, v2
    global_load_dword v251, v2, s[74:75]
    s_lshl_b32 s72, s2, 15
    s_add_u32 s40, s18, s72
    s_addc_u32 s41, s19, 0
    s_mov_b32 s42, 32768
    s_mov_b32 s43, 0x20000
    s_add_u32 s48, s18, 8388608
    s_addc_u32 s49, s19, 0
    s_mov_b32 s50, 16384
    s_mov_b32 s51, 0x20000
    s_mov_b32 s52, s14
    s_mov_b32 s53, s15
    s_mov_b32 s54, 1048576
    s_mov_b32 s55, 0x20000
    v_lshlrev_b32 v3, 13, v11
    v_lshl_add_u32 v3, v12, 4, v3
    s_lshl_b32 s72, s23, 8
    v_add_u32 v3, s72, v3
    v_add_u32 v4, 4096, v3
    v_xor_b32 v9, v12, v11
    v_lshlrev_b32 v9, 4, v9
    v_lshl_add_u32 v9, v12, 10, v9
    v_add_u32 v9, 131072, v9
    v_and_b32 v7, 3, v0
    v_lshlrev_b32 v7, 2, v7
    v_add_u32 v7, 114688, v7
    s_lshl_b32 s72, s23, 2
    s_add_u32 s72, s72, 114688
    v_mov_b32 v8, s72
    v_mov_b32 v16, 0
    v_mov_b32 v17, 0
    v_mov_b32 v18, 0
    v_mov_b32 v19, 0
    v_mov_b32 v20, 0
    v_mov_b32 v21, 0
    v_mov_b32 v22, 0
    v_mov_b32 v23, 0
    v_mov_b32 v24, 0
    v_mov_b32 v25, 0
    v_mov_b32 v26, 0
    v_mov_b32 v27, 0
    v_mov_b32 v28, 0
    v_mov_b32 v29, 0
    v_mov_b32 v30, 0
    v_mov_b32 v31, 0
    v_mov_b32 v32, 0
    v_mov_b32 v33, 0
    v_mov_b32 v34, 0
    v_mov_b32 v35, 0
    v_mov_b32 v36, 0
    v_mov_b32 v37, 0
    v_mov_b32 v38, 0
    v_mov_b32 v39, 0
    v_mov_b32 v40, 0
    v_mov_b32 v41, 0
    v_mov_b32 v42, 0
    v_mov_b32 v43, 0
    v_mov_b32 v44, 0
    v_mov_b32 v45, 0
    v_mov_b32 v46, 0
    v_mov_b32 v47, 0
    v_mov_b32 v48, 0
    v_mov_b32 v49, 0
    v_mov_b32 v50, 0
    v_mov_b32 v51, 0
    v_mov_b32 v52, 0
    v_mov_b32 v53, 0
    v_mov_b32 v54, 0
    v_mov_b32 v55, 0
    v_mov_b32 v56, 0
    v_mov_b32 v57, 0
    v_mov_b32 v58, 0
    v_mov_b32 v59, 0
    v_mov_b32 v60, 0
    v_mov_b32 v61, 0
    v_mov_b32 v62, 0
    v_mov_b32 v63, 0
    v_mov_b32 v64, 0
    v_mov_b32 v65, 0
    v_mov_b32 v66, 0
    v_mov_b32 v67, 0
    v_mov_b32 v68, 0
    v_mov_b32 v69, 0
    v_mov_b32 v70, 0
    v_mov_b32 v71, 0
    v_mov_b32 v72, 0
    v_mov_b32 v73, 0
    v_mov_b32 v74, 0
    v_mov_b32 v75, 0
    v_mov_b32 v76, 0
    v_mov_b32 v77, 0
    v_mov_b32 v78, 0
    v_mov_b32 v79, 0
    s_waitcnt vmcnt(21)
    s_barrier
    s_cmp_eq_u32 s23, 0
    s_cbranch_scc0 L_b1_nocnt
    s_lshl_b32 s74, s22, 2
    v_mov_b32 v14, s74
    v_mov_b32 v15, 1
    v_cmp_eq_u32 vcc, 0, v0
    s_and_saveexec_b64 s[72:73], vcc
    global_atomic_add v14, v15, s[16:17] sc1
    s_mov_b64 exec, s[72:73]
L_b1_nocnt:
    s_barrier
    s_waitcnt vmcnt(1)
    v_mov_b32 v14, 7
    ds_write_b32 v8, v14
L_g1_1:
    ds_read_b32 v14, v7 offset:16
    s_waitcnt lgkmcnt(0)
    v_cmp_gt_u32 vcc, 1, v14
    s_cbranch_vccz L_g1_1_ok
    s_cmp_eq_u32 s63, 0
    s_cbranch_scc1 L_g1_1_ok
    s_sub_u32 s63, s63, 1
    s_sleep 2
    s_branch L_g1_1
L_g1_1_ok:
    s_add_u32 s60, s58, s59
    s_and_b32 s69, s60, 6
    s_and_b32 s60, s60, 1
    s_lshl_b32 s69, s69, 1
    s_or_b32 s60, s60, s69
    s_and_b32 s69, s59, 8
    s_lshr_b32 s69, s69, 2
    s_or_b32 s60, s60, s69
    s_lshl_b32 s60, s60, 15
    s_add_u32 s59, s59, 1
    buffer_load_dwordx4 v[80:83], v3, s[36:39], s60 offen offset:0
    buffer_load_dwordx4 v[84:87], v3, s[36:39], s60 offen offset:1024
    buffer_load_dwordx4 v[88:91], v3, s[36:39], s60 offen offset:2048
    buffer_load_dwordx4 v[92:95], v3, s[36:39], s60 offen offset:3072
    buffer_load_dwordx4 v[96:99], v4, s[36:39], s60 offen offset:0
    buffer_load_dwordx4 v[100:103], v4, s[36:39], s60 offen offset:1024
    buffer_load_dwordx4 v[104:107], v4, s[36:39], s60 offen offset:2048
    buffer_load_dwordx4 v[108:111], v4, s[36:39], s60 offen offset:3072
    s_add_u32 s60, s58, s59
    s_and_b32 s69, s60, 6
    s_and_b32 s60, s60, 1
    s_lshl_b32 s69, s69, 1
    s_or_b32 s60, s60, s69
    s_and_b32 s69, s59, 8
    s_lshr_b32 s69, s69, 2
    s_or_b32 s60, s60, s69
    s_lshl_b32 s60, s60, 15
    s_add_u32 s59, s59, 1
    buffer_load_dwordx4 v[112:115], v3, s[36:39], s60 offen offset:0
    buffer_load_dwordx4 v[116:119], v3, s[36:39], s60 offen offset:1024
    buffer_load_dwordx4 v[120:123], v3, s[36:39], s60 offen offset:2048
    buffer_load_dwordx4 v[124:127], v3, s[36:39], s60 offen offset:3072
    buffer_load_dwordx4 v[128:131], v4, s[36:39], s60 offen offset:0
    buffer_load_dwordx4 v[132:135], v4, s[36:39], s60 offen offset:1024
    buffer_load_dwordx4 v[136:139], v4, s[36:39], s60 offen offset:2048
    buffer_load_dwordx4 v[140:143], v4, s[36:39], s60 offen offset:3072
    s_add_u32 s60, s58, s59
    s_and_b32 s69, s60, 6
    s_and_b32 s60, s60, 1
    s_lshl_b32 s69, s69, 1
    s_or_b32 s60, s60, s69
    s_and_b32 s69, s59, 8
    s_lshr_b32 s69, s69, 2
    s_or_b32 s60, s60, s69
    s_lshl_b32 s60, s60, 15
    s_add_u32 s59, s59, 1
    buffer_load_dwordx4 v[144:147], v3, s[36:39], s60 offen offset:0
    buffer_load_dwordx4 v[148:151], v3, s[36:39], s60 offen offset:1024
    buffer_load_dwordx4 v[152:155], v3, s[36:39], s60 offen offset:2048
    buffer_load_dwordx4 v[156:159], v3, s[36:39], s60 offen offset:3072
    buffer_load_dwordx4 v[160:163], v4, s[36:39], s60 offen offset:0
    buffer_load_dwordx4 v[164:167], v4, s[36:39], s60 offen offset:1024
    buffer_load_dwordx4 v[168:171], v4, s[36:39], s60 offen offset:2048
    buffer_load_dwordx4 v[172:175], v4, s[36:39], s60 offen offset:3072
L_g1_2:
    ds_read_b32 v14, v7 offset:16
    s_waitcnt lgkmcnt(0)
    v_cmp_gt_u32 vcc, 2, v14
    s_cbranch_vccz L_g1_2_ok
    s_cmp_eq_u32 s63, 0
    s_cbranch_scc1 L_g1_2_ok
    s_sub_u32 s63, s63, 1
    s_sleep 2
    s_branch L_g1_2
L_g1_2_ok:
    s_add_u32 m0, s66, 131072
    s_mov_b32 s70, 114688
    buffer_load_dwordx4 v5, s[28:31], s70 offen nt lds
    s_add_u32 m0, s66, 135168
    s_mov_b32 s70, 118784
    buffer_load_dwordx4 v5, s[28:31], s70 offen nt lds
    s_add_u32 m0, s66, 139264
    s_mov_b32 s70, 122880
    buffer_load_dwordx4 v5, s[28:31], s70 offen nt lds
    s_add_u32 m0, s66, 143360
    s_mov_b32 s70, 126976
    buffer_load_dwordx4 v5, s[28:31], s70 offen nt lds
    s_add_u32 m0, s66, 147456
    s_mov_b32 s70, 0
    buffer_load_dwordx4 v6, s[32:35], s70 offen nt lds
    s_add_u32 m0, s66, 151552
    s_mov_b32 s70, 8192
    buffer_load_dwordx4 v6, s[32:35], s70 offen nt lds
    s_add_u32 m0, s66, 155648
    s_mov_b32 s70, 16384
    buffer_load_dwordx4 v6, s[32:35], s70 offen nt lds
    s_add_u32 m0, s66, 159744
    s_mov_b32 s70, 24576
    buffer_load_dwordx4 v6, s[32:35], s70 offen nt lds
L_g1_3:
    ds_read_b32 v14, v7 offset:16
    s_waitcnt lgkmcnt(0)
    v_cmp_gt_u32 vcc, 3, v14
    s_cbranch_vccz L_g1_3_ok
    s_cmp_eq_u32 s63, 0
    s_cbranch_scc1 L_g1_3_ok
    s_sub_u32 s63, s63, 1
    s_sleep 2
    s_branch L_g1_3
L_g1_3_ok:
    s_add_u32 m0, s66, 0
    s_mov_b32 s70, 32768
    buffer_load_dwordx4 v6, s[32:35], s70 offen nt lds
    s_add_u32 m0, s66, 4096
    s_mov_b32 s70, 40960
    buffer_load_dwordx4 v6, s[32:35], s70 offen nt lds
    s_add_u32 m0, s66, 8192
    s_mov_b32 s70, 49152
    buffer_load_dwordx4 v6, s[32:35], s70 offen nt lds
    s_add_u32 m0, s66, 12288
    s_mov_b32 s70, 57344
    buffer_load_dwordx4 v6, s[32:35], s70 offen nt lds
    s_waitcnt vmcnt(8)
    v_mov_b32 v14, 8
    ds_write_b32 v8, v14
L_g1_4:
    ds_read_b32 v14, v7 offset:16
    s_waitcnt lgkmcnt(0)
    v_cmp_gt_u32 vcc, 4, v14
    s_cbranch_vccz L_g1_4_ok
    s_cmp_eq_u32 s63, 0
    s_cbranch_scc1 L_g1_4_ok
    s_sub_u32 s63, s63, 1
    s_sleep 2
    s_branch L_g1_4
L_g1_4_ok:
    s_add_u32 m0, s66, 16384
    s_mov_b32 s70, 65536
    buffer_load_dwordx4 v6, s[32:35], s70 offen nt lds
    s_add_u32 m0, s66, 20480
    s_mov_b32 s70, 73728
    buffer_load_dwordx4 v6, s[32:35], s70 offen nt lds
    s_add_u32 m0, s66, 24576
    s_mov_b32 s70, 81920
    buffer_load_dwordx4 v6, s[32:35], s70 offen nt lds
    s_add_u32 m0, s66, 28672
    s_mov_b32 s70, 90112
    buffer_load_dwordx4 v6, s[32:35], s70 offen nt lds
    s_waitcnt vmcnt(8)
    v_mov_b32 v14, 9
    ds_write_b32 v8, v14
L_g1_5:
    ds_read_b32 v14, v7 offset:16
    s_waitcnt lgkmcnt(0)
    v_cmp_gt_u32 vcc, 5, v14
    s_cbranch_vccz L_g1_5_ok
    s_cmp_eq_u32 s63, 0
    s_cbranch_scc1 L_g1_5_ok
    s_sub_u32 s63, s63, 1
    s_sleep 2
    s_branch L_g1_5
L_g1_5_ok:
    s_add_u32 m0, s66, 32768
    s_mov_b32 s70, 98304
    buffer_load_dwordx4 v6, s[32:35], s70 offen nt lds
    s_add_u32 m0, s66, 36864
    s_mov_b32 s70, 106496
    buffer_load_dwordx4 v6, s[32:35], s70 offen nt lds
    s_add_u32 m0, s66, 40960
    s_mov_b32 s70, 114688
    buffer_load_dwordx4 v6, s[32:35], s70 offen nt lds
    s_add_u32 m0, s66, 45056
    s_mov_b32 s70, 122880
    buffer_load_dwordx4 v6, s[32:35], s70 offen nt lds
    s_waitcnt vmcnt(8)
    v_mov_b32 v14, 10
    ds_write_b32 v8, v14
L_g1_6:
    ds_read_b32 v14, v7 offset:16
    s_waitcnt lgkmcnt(0)
    v_cmp_gt_u32 vcc, 6, v14
    s_cbranch_vccz L_g1_6_ok
    s_cmp_eq_u32 s63, 0
    s_cbranch_scc1 L_g1_6_ok
    s_sub_u32 s63, s63, 1
    s_sleep 2
    s_branch L_g1_6
L_g1_6_ok:
    s_add_u32 m0, s66, 49152
    s_mov_b32 s70, 128
    buffer_load_dwordx4 v6, s[32:35], s70 offen nt lds
    s_add_u32 m0, s66, 53248
    s_mov_b32 s70, 8320
    buffer_load_dwordx4 v6, s[32:35], s70 offen nt lds
    s_add_u32 m0, s66, 57344
    s_mov_b32 s70, 16512
    buffer_load_dwordx4 v6, s[32:35], s70 offen nt lds
    s_add_u32 m0, s66, 61440
    s_mov_b32 s70, 24704
    buffer_load_dwordx4 v6, s[32:35], s70 offen nt lds
    s_waitcnt vmcnt(8)
    v_mov_b32 v14, 11
    ds_write_b32 v8, v14
L_g1_7:
    ds_read_b32 v14, v7 offset:16
    s_waitcnt lgkmcnt(0)
    v_cmp_gt_u32 vcc, 7, v14
    s_cbranch_vccz L_g1_7_ok
    s_cmp_eq_u32 s63, 0
    s_cbranch_scc1 L_g1_7_ok
    s_sub_u32 s63, s63, 1
    s_sleep 2
    s_branch L_g1_7
L_g1_7_ok:
    s_add_u32 m0, s66, 65536
    s_mov_b32 s70, 32896
    buffer_load_dwordx4 v6, s[32:35], s70 offen nt lds
    s_add_u32 m0, s66, 69632
    s_mov_b32 s70, 41088
    buffer_load_dwordx4 v6, s[32:35], s70 offen nt lds
    s_add_u32 m0, s66, 73728
    s_mov_b32 s70, 49280
    buffer_load_dwordx4 v6, s[32:35], s70 offen nt lds
    s_add_u32 m0, s66, 77824
    s_mov_b32 s70, 57472
    buffer_load_dwordx4 v6, s[32:35], s70 offen nt lds
    s_waitcnt vmcnt(8)
    v_mov_b32 v14, 12
    ds_write_b32 v8, v14
L_g1_8:
    ds_read_b32 v14, v7 offset:16
    s_waitcnt lgkmcnt(0)
    v_cmp_gt_u32 vcc, 8, v14
    s_cbranch_vccz L_g1_8_ok
    s_cmp_eq_u32 s63, 0
    s_cbranch_scc1 L_g1_8_ok
    s_sub_u32 s63, s63, 1
    s_sleep 2
    s_branch L_g1_8
L_g1_8_ok:
    s_add_u32 m0, s66, 81920
    s_mov_b32 s70, 65664
    buffer_load_dwordx4 v6, s[32:35], s70 offen nt lds
    s_add_u32 m0, s66, 86016
    s_mov_b32 s70, 73856
    buffer_load_dwordx4 v6, s[32:35], s70 offen nt lds
    s_add_u32 m0, s66, 90112
    s_mov_b32 s70, 82048
    buffer_load_dwordx4 v6, s[32:35], s70 offen nt lds
    s_add_u32 m0, s66, 94208
    s_mov_b32 s70, 90240
    buffer_load_dwordx4 v6, s[32:35], s70 offen nt lds
    s_waitcnt vmcnt(8)
    v_mov_b32 v14, 13
    ds_write_b32 v8, v14
L_g1_9:
    ds_read_b32 v14, v7 offset:16
    s_waitcnt lgkmcnt(0)
    v_cmp_gt_u32 vcc, 9, v14
    s_cbranch_vccz L_g1_9_ok
    s_cmp_eq_u32 s63, 0
    s_cbranch_scc1 L_g1_9_ok
    s_sub_u32 s63, s63, 1
    s_sleep 2
    s_branch L_g1_9
L_g1_9_ok:
    s_add_u32 m0, s66, 98304
    s_mov_b32 s70, 98432
    buffer_load_dwordx4 v6, s[32:35], s70 offen nt lds
    s_add_u32 m0, s66, 102400
    s_mov_b32 s70, 106624
    buffer_load_dwordx4 v6, s[32:35], s70 offen nt lds
    s_add_u32 m0, s66, 106496
    s_mov_b32 s70, 114816
    buffer_load_dwordx4 v6, s[32:35], s70 offen nt lds
    s_add_u32 m0, s66, 110592
    s_mov_b32 s70, 123008
    buffer_load_dwordx4 v6, s[32:35], s70 offen nt lds
    s_waitcnt vmcnt(8)
    v_mov_b32 v14, 14
    ds_write_b32 v8, v14
    s_waitcnt vmcnt(4)
    v_mov_b32 v14, 15
    ds_write_b32 v8, v14
    s_waitcnt vmcnt(0)
    v_mov_b32 v14, 16
    ds_write_b32 v8, v14
    s_lshl_b32 s70, s22, 2
    v_mov_b32 v241, s70
    s_branch L_outproj
L_outproj:
L_ox1:
    ds_read_b32 v14, v7 offset:32
    s_waitcnt lgkmcnt(0)
    v_cmp_gt_u32 vcc, 1, v14
    s_cbranch_vccz L_ox1_ok
    s_cmp_eq_u32 s63, 0
    s_cbranch_scc1 L_ox1_ok
    s_sub_u32 s63, s63, 1
    s_sleep 1
    s_branch L_ox1
L_ox1_ok:
    s_setprio 1
    s_and_b32 s58, s58, 7
    s_add_u32 s62, s58, s61
    s_and_b32 s69, s62, 6
    s_and_b32 s62, s62, 1
    s_lshl_b32 s69, s69, 1
    s_or_b32 s62, s62, s69
    s_and_b32 s69, s61, 8
    s_lshr_b32 s69, s69, 2
    s_or_b32 s62, s62, s69
    s_lshl_b32 s62, s62, 6
    s_add_u32 s61, s61, 1
    v_xor_b32 v10, s62, v9
    ds_read_b128 v[224:227], v10
    ds_read_b128 v[228:231], v10 offset:16384
    s_mov_b32 s64, 0
L_o_loop:
    s_add_u32 s60, s58, s59
    s_and_b32 s69, s60, 6
    s_and_b32 s60, s60, 1
    s_lshl_b32 s69, s69, 1
    s_or_b32 s60, s60, s69
    s_and_b32 s69, s59, 8
    s_lshr_b32 s69, s69, 2
    s_or_b32 s60, s60, s69
    s_lshl_b32 s60, s60, 15
    s_add_u32 s59, s59, 1
    s_add_u32 s62, s58, s61
    s_and_b32 s69, s62, 6
    s_and_b32 s62, s62, 1
    s_lshl_b32 s69, s69, 1
    s_or_b32 s62, s62, s69
    s_and_b32 s69, s61, 8
    s_lshr_b32 s69, s69, 2
    s_or_b32 s62, s62, s69
    s_lshl_b32 s62, s62, 6
    s_add_u32 s61, s61, 1
    v_xor_b32 v10, s62, v9
    ds_read_b128 v[232:235], v10
    ds_read_b128 v[236:239], v10 offset:16384
    s_waitcnt vmcnt(16) lgkmcnt(2)
    v_perm_b32 v208, v84, v80, s56
    v_perm_b32 v209, v92, v88, s56
    v_perm_b32 v210, v100, v96, s56
    v_perm_b32 v211, v108, v104, s56
    v_perm_b32 v212, v84, v80, s57
    v_perm_b32 v213, v92, v88, s57
    v_perm_b32 v214, v100, v96, s57
    v_perm_b32 v215, v108, v104, s57
    v_mfma_f32_16x16x32_bf16 v[16:19], v[208:211], v[224:227], v[16:19]
    buffer_load_dwordx4 v[176:179], v3, s[36:39], s60 offen offset:0
    v_perm_b32 v216, v85, v81, s56
    v_perm_b32 v217, v93, v89, s56
    v_mfma_f32_16x16x32_bf16 v[20:23], v[208:211], v[228:231], v[20:23]
    v_perm_b32 v218, v101, v97, s56
    v_perm_b32 v219, v109, v105, s56
    v_mfma_f32_16x16x32_bf16 v[24:27], v[212:215], v[224:227], v[24:27]
    buffer_load_dwordx4 v[180:183], v3, s[36:39], s60 offen offset:1024
    v_perm_b32 v220, v85, v81, s57
    v_perm_b32 v221, v93, v89, s57
    v_mfma_f32_16x16x32_bf16 v[28:31], v[212:215], v[228:231], v[28:31]
    v_perm_b32 v222, v101, v97, s57
    v_perm_b32 v223, v109, v105, s57
    v_mfma_f32_16x16x32_bf16 v[32:35], v[216:219], v[224:227], v[32:35]
    buffer_load_dwordx4 v[184:187], v3, s[36:39], s60 offen offset:2048
    v_perm_b32 v208, v86, v82, s56
    v_perm_b32 v209, v94, v90, s56
    v_mfma_f32_16x16x32_bf16 v[36:39], v[216:219], v[228:231], v[36:39]
    v_perm_b32 v210, v102, v98, s56
    v_perm_b32 v211, v110, v106, s56
    v_mfma_f32_16x16x32_bf16 v[40:43], v[220:223], v[224:227], v[40:43]
    buffer_load_dwordx4 v[188:191], v3, s[36:39], s60 offen offset:3072
    v_perm_b32 v212, v86, v82, s57
    v_perm_b32 v213, v94, v90, s57
    v_mfma_f32_16x16x32_bf16 v[44:47], v[220:223], v[228:231], v[44:47]
    v_perm_b32 v214, v102, v98, s57
    v_perm_b32 v215, v110, v106, s57
    v_mfma_f32_16x16x32_bf16 v[48:51], v[208:211], v[224:227], v[48:51]
    buffer_load_dwordx4 v[192:195], v4, s[36:39], s60 offen offset:0
    v_perm_b32 v216, v87, v83, s56
    v_perm_b32 v217, v95, v91, s56
    v_mfma_f32_16x16x32_bf16 v[52:55], v[208:211], v[228:231], v[52:55]
    v_perm_b32 v218, v103, v99, s56
    v_perm_b32 v219, v111, v107, s56
    v_mfma_f32_16x16x32_bf16 v[56:59], v[212:215], v[224:227], v[56:59]
    buffer_load_dwordx4 v[196:199], v4, s[36:39], s60 offen offset:1024
    v_perm_b32 v220, v87, v83, s57
    v_perm_b32 v221, v95, v91, s57
    v_mfma_f32_16x16x32_bf16 v[60:63], v[212:215], v[228:231], v[60:63]
    v_perm_b32 v222, v103, v99, s57
    v_perm_b32 v223, v111, v107, s57
    v_mfma_f32_16x16x32_bf16 v[64:67], v[216:219], v[224:227], v[64:67]
    buffer_load_dwordx4 v[200:203], v4, s[36:39], s60 offen offset:2048
    v_mfma_f32_16x16x32_bf16 v[68:71], v[216:219], v[228:231], v[68:71]
    v_mfma_f32_16x16x32_bf16 v[72:75], v[220:223], v[224:227], v[72:75]
    buffer_load_dwordx4 v[204:207], v4, s[36:39], s60 offen offset:3072
    v_mfma_f32_16x16x32_bf16 v[76:79], v[220:223], v[228:231], v[76:79]
    s_add_u32 s60, s58, s59
    s_and_b32 s69, s60, 6
    s_and_b32 s60, s60, 1
    s_lshl_b32 s69, s69, 1
    s_or_b32 s60, s60, s69
    s_and_b32 s69, s59, 8
    s_lshr_b32 s69, s69, 2
    s_or_b32 s60, s60, s69
    s_lshl_b32 s60, s60, 15
    s_add_u32 s59, s59, 1
    s_add_u32 s62, s58, s61
    s_and_b32 s69, s62, 6
    s_and_b32 s62, s62, 1
    s_lshl_b32 s69, s69, 1
    s_or_b32 s62, s62, s69
    s_and_b32 s69, s61, 8
    s_lshr_b32 s69, s69, 2
    s_or_b32 s62, s62, s69
    s_lshl_b32 s62, s62, 6
    s_add_u32 s61, s61, 1
    v_xor_b32 v10, s62, v9
    ds_read_b128 v[224:227], v10
    ds_read_b128 v[228:231], v10 offset:16384
    s_waitcnt vmcnt(16) lgkmcnt(2)
    v_perm_b32 v208, v116, v112, s56
    v_perm_b32 v209, v124, v120, s56
    v_perm_b32 v210, v132, v128, s56
    v_perm_b32 v211, v140, v136, s56
    v_perm_b32 v212, v116, v112, s57
    v_perm_b32 v213, v124, v120, s57
    v_perm_b32 v214, v132, v128, s57
    v_perm_b32 v215, v140, v136, s57
    v_mfma_f32_16x16x32_bf16 v[16:19], v[208:211], v[232:235], v[16:19]
    buffer_load_dwordx4 v[80:83], v3, s[36:39], s60 offen offset:0
    v_perm_b32 v216, v117, v113, s56
    v_perm_b32 v217, v125, v121, s56
    v_mfma_f32_16x16x32_bf16 v[20:23], v[208:211], v[236:239], v[20:23]
    v_perm_b32 v218, v133, v129, s56
    v_perm_b32 v219, v141, v137, s56
    v_mfma_f32_16x16x32_bf16 v[24:27], v[212:215], v[232:235], v[24:27]
    buffer_load_dwordx4 v[84:87], v3, s[36:39], s60 offen offset:1024
    v_perm_b32 v220, v117, v113, s57
    v_perm_b32 v221, v125, v121, s57
    v_mfma_f32_16x16x32_bf16 v[28:31], v[212:215], v[236:239], v[28:31]
    v_perm_b32 v222, v133, v129, s57
    v_perm_b32 v223, v141, v137, s57
    v_mfma_f32_16x16x32_bf16 v[32:35], v[216:219], v[232:235], v[32:35]
    buffer_load_dwordx4 v[88:91], v3, s[36:39], s60 offen offset:2048
    v_perm_b32 v208, v118, v114, s56
    v_perm_b32 v209, v126, v122, s56
    v_mfma_f32_16x16x32_bf16 v[36:39], v[216:219], v[236:239], v[36:39]
    v_perm_b32 v210, v134, v130, s56
    v_perm_b32 v211, v142, v138, s56
    v_mfma_f32_16x16x32_bf16 v[40:43], v[220:223], v[232:235], v[40:43]
    buffer_load_dwordx4 v[92:95], v3, s[36:39], s60 offen offset:3072
    v_perm_b32 v212, v118, v114, s57
    v_perm_b32 v213, v126, v122, s57
    v_mfma_f32_16x16x32_bf16 v[44:47], v[220:223], v[236:239], v[44:47]
    v_perm_b32 v214, v134, v130, s57
    v_perm_b32 v215, v142, v138, s57
    v_mfma_f32_16x16x32_bf16 v[48:51], v[208:211], v[232:235], v[48:51]
    buffer_load_dwordx4 v[96:99], v4, s[36:39], s60 offen offset:0
    v_perm_b32 v216, v119, v115, s56
    v_perm_b32 v217, v127, v123, s56
    v_mfma_f32_16x16x32_bf16 v[52:55], v[208:211], v[236:239], v[52:55]
    v_perm_b32 v218, v135, v131, s56
    v_perm_b32 v219, v143, v139, s56
    v_mfma_f32_16x16x32_bf16 v[56:59], v[212:215], v[232:235], v[56:59]
    buffer_load_dwordx4 v[100:103], v4, s[36:39], s60 offen offset:1024
    v_perm_b32 v220, v119, v115, s57
    v_perm_b32 v221, v127, v123, s57
    v_mfma_f32_16x16x32_bf16 v[60:63], v[212:215], v[236:239], v[60:63]
    v_perm_b32 v222, v135, v131, s57
    v_perm_b32 v223, v143, v139, s57
    v_mfma_f32_16x16x32_bf16 v[64:67], v[216:219], v[232:235], v[64:67]
    buffer_load_dwordx4 v[104:107], v4, s[36:39], s60 offen offset:2048
    v_mfma_f32_16x16x32_bf16 v[68:71], v[216:219], v[236:239], v[68:71]
    v_mfma_f32_16x16x32_bf16 v[72:75], v[220:223], v[232:235], v[72:75]
    buffer_load_dwordx4 v[108:111], v4, s[36:39], s60 offen offset:3072
    v_mfma_f32_16x16x32_bf16 v[76:79], v[220:223], v[236:239], v[76:79]
    s_add_u32 s60, s58, s59
    s_and_b32 s69, s60, 6
    s_and_b32 s60, s60, 1
    s_lshl_b32 s69, s69, 1
    s_or_b32 s60, s60, s69
    s_and_b32 s69, s59, 8
    s_lshr_b32 s69, s69, 2
    s_or_b32 s60, s60, s69
    s_lshl_b32 s60, s60, 15
    s_add_u32 s59, s59, 1
    s_add_u32 s62, s58, s61
    s_and_b32 s69, s62, 6
    s_and_b32 s62, s62, 1
    s_lshl_b32 s69, s69, 1
    s_or_b32 s62, s62, s69
    s_and_b32 s69, s61, 8
    s_lshr_b32 s69, s69, 2
    s_or_b32 s62, s62, s69
    s_lshl_b32 s62, s62, 6
    s_add_u32 s61, s61, 1
    v_xor_b32 v10, s62, v9
    ds_read_b128 v[232:235], v10
    ds_read_b128 v[236:239], v10 offset:16384
    s_waitcnt vmcnt(16) lgkmcnt(2)
    v_perm_b32 v208, v148, v144, s56
    v_perm_b32 v209, v156, v152, s56
    v_perm_b32 v210, v164, v160, s56
    v_perm_b32 v211, v172, v168, s56
    v_perm_b32 v212, v148, v144, s57
    v_perm_b32 v213, v156, v152, s57
    v_perm_b32 v214, v164, v160, s57
    v_perm_b32 v215, v172, v168, s57
    v_mfma_f32_16x16x32_bf16 v[16:19], v[208:211], v[224:227], v[16:19]
    buffer_load_dwordx4 v[112:115], v3, s[36:39], s60 offen offset:0
    v_perm_b32 v216, v149, v145, s56
    v_perm_b32 v217, v157, v153, s56
    v_mfma_f32_16x16x32_bf16 v[20:23], v[208:211], v[228:231], v[20:23]
    v_perm_b32 v218, v165, v161, s56
    v_perm_b32 v219, v173, v169, s56
    v_mfma_f32_16x16x32_bf16 v[24:27], v[212:215], v[224:227], v[24:27]
    buffer_load_dwordx4 v[116:119], v3, s[36:39], s60 offen offset:1024
    v_perm_b32 v220, v149, v145, s57
    v_perm_b32 v221, v157, v153, s57
    v_mfma_f32_16x16x32_bf16 v[28:31], v[212:215], v[228:231], v[28:31]
    v_perm_b32 v222, v165, v161, s57
    v_perm_b32 v223, v173, v169, s57
    v_mfma_f32_16x16x32_bf16 v[32:35], v[216:219], v[224:227], v[32:35]
    buffer_load_dwordx4 v[120:123], v3, s[36:39], s60 offen offset:2048
    v_perm_b32 v208, v150, v146, s56
    v_perm_b32 v209, v158, v154, s56
    v_mfma_f32_16x16x32_bf16 v[36:39], v[216:219], v[228:231], v[36:39]
    v_perm_b32 v210, v166, v162, s56
    v_perm_b32 v211, v174, v170, s56
    v_mfma_f32_16x16x32_bf16 v[40:43], v[220:223], v[224:227], v[40:43]
    buffer_load_dwordx4 v[124:127], v3, s[36:39], s60 offen offset:3072
    v_perm_b32 v212, v150, v146, s57
    v_perm_b32 v213, v158, v154, s57
    v_mfma_f32_16x16x32_bf16 v[44:47], v[220:223], v[228:231], v[44:47]
    v_perm_b32 v214, v166, v162, s57
    v_perm_b32 v215, v174, v170, s57
    v_mfma_f32_16x16x32_bf16 v[48:51], v[208:211], v[224:227], v[48:51]
    buffer_load_dwordx4 v[128:131], v4, s[36:39], s60 offen offset:0
    v_perm_b32 v216, v151, v147, s56
    v_perm_b32 v217, v159, v155, s56
    v_mfma_f32_16x16x32_bf16 v[52:55], v[208:211], v[228:231], v[52:55]
    v_perm_b32 v218, v167, v163, s56
    v_perm_b32 v219, v175, v171, s56
    v_mfma_f32_16x16x32_bf16 v[56:59], v[212:215], v[224:227], v[56:59]
    buffer_load_dwordx4 v[132:135], v4, s[36:39], s60 offen offset:1024
    v_perm_b32 v220, v151, v147, s57
    v_perm_b32 v221, v159, v155, s57
    v_mfma_f32_16x16x32_bf16 v[60:63], v[212:215], v[228:231], v[60:63]
    v_perm_b32 v222, v167, v163, s57
    v_perm_b32 v223, v175, v171, s57
    v_mfma_f32_16x16x32_bf16 v[64:67], v[216:219], v[224:227], v[64:67]
    buffer_load_dwordx4 v[136:139], v4, s[36:39], s60 offen offset:2048
    v_mfma_f32_16x16x32_bf16 v[68:71], v[216:219], v[228:231], v[68:71]
    v_mfma_f32_16x16x32_bf16 v[72:75], v[220:223], v[224:227], v[72:75]
    buffer_load_dwordx4 v[140:143], v4, s[36:39], s60 offen offset:3072
    v_mfma_f32_16x16x32_bf16 v[76:79], v[220:223], v[228:231], v[76:79]
    s_add_u32 s60, s58, s59
    s_and_b32 s69, s60, 6
    s_and_b32 s60, s60, 1
    s_lshl_b32 s69, s69, 1
    s_or_b32 s60, s60, s69
    s_and_b32 s69, s59, 8
    s_lshr_b32 s69, s69, 2
    s_or_b32 s60, s60, s69
    s_lshl_b32 s60, s60, 15
    s_add_u32 s59, s59, 1
    s_cmp_eq_u32 s64, 1
    s_cbranch_scc0 L_nopre8
L_ox2:
    ds_read_b32 v14, v7 offset:32
    s_waitcnt lgkmcnt(0)
    v_cmp_gt_u32 vcc, 2, v14
    s_cbranch_vccz L_ox2_ok
    s_cmp_eq_u32 s63, 0
    s_cbranch_scc1 L_ox2_ok
    s_sub_u32 s63, s63, 1
    s_sleep 1
    s_branch L_ox2
L_ox2_ok:
L_nopre8:
    s_add_u32 s62, s58, s61
    s_and_b32 s69, s62, 6
    s_and_b32 s62, s62, 1
    s_lshl_b32 s69, s69, 1
    s_or_b32 s62, s62, s69
    s_and_b32 s69, s61, 8
    s_lshr_b32 s69, s69, 2
    s_or_b32 s62, s62, s69
    s_lshl_b32 s62, s62, 6
    s_add_u32 s61, s61, 1
    v_xor_b32 v10, s62, v9
    ds_read_b128 v[224:227], v10
    ds_read_b128 v[228:231], v10 offset:16384
    s_waitcnt vmcnt(16) lgkmcnt(2)
    v_perm_b32 v208, v180, v176, s56
    v_perm_b32 v209, v188, v184, s56
    v_perm_b32 v210, v196, v192, s56
    v_perm_b32 v211, v204, v200, s56
    v_perm_b32 v212, v180, v176, s57
    v_perm_b32 v213, v188, v184, s57
    v_perm_b32 v214, v196, v192, s57
    v_perm_b32 v215, v204, v200, s57
    v_mfma_f32_16x16x32_bf16 v[16:19], v[208:211], v[232:235], v[16:19]
    buffer_load_dwordx4 v[144:147], v3, s[36:39], s60 offen offset:0
    v_perm_b32 v216, v181, v177, s56
    v_perm_b32 v217, v189, v185, s56
    v_mfma_f32_16x16x32_bf16 v[20:23], v[208:211], v[236:239], v[20:23]
    v_perm_b32 v218, v197, v193, s56
    v_perm_b32 v219, v205, v201, s56
    v_mfma_f32_16x16x32_bf16 v[24:27], v[212:215], v[232:235], v[24:27]
    buffer_load_dwordx4 v[148:151], v3, s[36:39], s60 offen offset:1024
    v_perm_b32 v220, v181, v177, s57
    v_perm_b32 v221, v189, v185, s57
    v_mfma_f32_16x16x32_bf16 v[28:31], v[212:215], v[236:239], v[28:31]
    v_perm_b32 v222, v197, v193, s57
    v_perm_b32 v223, v205, v201, s57
    v_mfma_f32_16x16x32_bf16 v[32:35], v[216:219], v[232:235], v[32:35]
    buffer_load_dwordx4 v[152:155], v3, s[36:39], s60 offen offset:2048
    v_perm_b32 v208, v182, v178, s56
    v_perm_b32 v209, v190, v186, s56
    v_mfma_f32_16x16x32_bf16 v[36:39], v[216:219], v[236:239], v[36:39]
    v_perm_b32 v210, v198, v194, s56
    v_perm_b32 v211, v206, v202, s56
    v_mfma_f32_16x16x32_bf16 v[40:43], v[220:223], v[232:235], v[40:43]
    buffer_load_dwordx4 v[156:159], v3, s[36:39], s60 offen offset:3072
    v_perm_b32 v212, v182, v178, s57
    v_perm_b32 v213, v190, v186, s57
    v_mfma_f32_16x16x32_bf16 v[44:47], v[220:223], v[236:239], v[44:47]
    v_perm_b32 v214, v198, v194, s57
    v_perm_b32 v215, v206, v202, s57
    v_mfma_f32_16x16x32_bf16 v[48:51], v[208:211], v[232:235], v[48:51]
    buffer_load_dwordx4 v[160:163], v4, s[36:39], s60 offen offset:0
    v_perm_b32 v216, v183, v179, s56
    v_perm_b32 v217, v191, v187, s56
    v_mfma_f32_16x16x32_bf16 v[52:55], v[208:211], v[236:239], v[52:55]
    v_perm_b32 v218, v199, v195, s56
    v_perm_b32 v219, v207, v203, s56
    v_mfma_f32_16x16x32_bf16 v[56:59], v[212:215], v[232:235], v[56:59]
    buffer_load_dwordx4 v[164:167], v4, s[36:39], s60 offen offset:1024
    v_perm_b32 v220, v183, v179, s57
    v_perm_b32 v221, v191, v187, s57
    v_mfma_f32_16x16x32_bf16 v[60:63], v[212:215], v[236:239], v[60:63]
    v_perm_b32 v222, v199, v195, s57
    v_perm_b32 v223, v207, v203, s57
    v_mfma_f32_16x16x32_bf16 v[64:67], v[216:219], v[232:235], v[64:67]
    buffer_load_dwordx4 v[168:171], v4, s[36:39], s60 offen offset:2048
    v_mfma_f32_16x16x32_bf16 v[68:71], v[216:219], v[236:239], v[68:71]
    v_mfma_f32_16x16x32_bf16 v[72:75], v[220:223], v[232:235], v[72:75]
    buffer_load_dwordx4 v[172:175], v4, s[36:39], s60 offen offset:3072
    v_mfma_f32_16x16x32_bf16 v[76:79], v[220:223], v[236:239], v[76:79]
    s_add_u32 s64, s64, 1
    s_cmp_lt_u32 s64, 3
    s_cbranch_scc1 L_o_loop
    s_add_u32 s60, s58, s59
    s_and_b32 s69, s60, 6
    s_and_b32 s60, s60, 1
    s_lshl_b32 s69, s69, 1
    s_or_b32 s60, s60, s69
    s_and_b32 s69, s59, 8
    s_lshr_b32 s69, s69, 2
    s_or_b32 s60, s60, s69
    s_lshl_b32 s60, s60, 15
    s_add_u32 s59, s59, 1
    s_add_u32 s62, s58, s61
    s_and_b32 s69, s62, 6
    s_and_b32 s62, s62, 1
    s_lshl_b32 s69, s69, 1
    s_or_b32 s62, s62, s69
    s_and_b32 s69, s61, 8
    s_lshr_b32 s69, s69, 2
    s_or_b32 s62, s62, s69
    s_lshl_b32 s62, s62, 6
    s_add_u32 s61, s61, 1
    v_xor_b32 v10, s62, v9
    ds_read_b128 v[232:235], v10
    ds_read_b128 v[236:239], v10 offset:16384
    s_waitcnt vmcnt(16) lgkmcnt(2)
    v_perm_b32 v208, v84, v80, s56
    v_perm_b32 v209, v92, v88, s56
    v_perm_b32 v210, v100, v96, s56
    v_perm_b32 v211, v108, v104, s56
    v_perm_b32 v212, v84, v80, s57
    v_perm_b32 v213, v92, v88, s57
    v_perm_b32 v214, v100, v96, s57
    v_perm_b32 v215, v108, v104, s57
    v_mfma_f32_16x16x32_bf16 v[16:19], v[208:211], v[224:227], v[16:19]
    buffer_load_dwordx4 v[176:179], v3, s[36:39], s60 offen offset:0
    v_perm_b32 v216, v85, v81, s56
    v_perm_b32 v217, v93, v89, s56
    v_mfma_f32_16x16x32_bf16 v[20:23], v[208:211], v[228:231], v[20:23]
    v_perm_b32 v218, v101, v97, s56
    v_perm_b32 v219, v109, v105, s56
    v_mfma_f32_16x16x32_bf16 v[24:27], v[212:215], v[224:227], v[24:27]
    buffer_load_dwordx4 v[180:183], v3, s[36:39], s60 offen offset:1024
    v_perm_b32 v220, v85, v81, s57
    v_perm_b32 v221, v93, v89, s57
    v_mfma_f32_16x16x32_bf16 v[28:31], v[212:215], v[228:231], v[28:31]
    v_perm_b32 v222, v101, v97, s57
    v_perm_b32 v223, v109, v105, s57
    v_mfma_f32_16x16x32_bf16 v[32:35], v[216:219], v[224:227], v[32:35]
    buffer_load_dwordx4 v[184:187], v3, s[36:39], s60 offen offset:2048
    v_perm_b32 v208, v86, v82, s56
    v_perm_b32 v209, v94, v90, s56
    v_mfma_f32_16x16x32_bf16 v[36:39], v[216:219], v[228:231], v[36:39]
    v_perm_b32 v210, v102, v98, s56
    v_perm_b32 v211, v110, v106, s56
    v_mfma_f32_16x16x32_bf16 v[40:43], v[220:223], v[224:227], v[40:43]
    buffer_load_dwordx4 v[188:191], v3, s[36:39], s60 offen offset:3072
    v_perm_b32 v212, v86, v82, s57
    v_perm_b32 v213, v94, v90, s57
    v_mfma_f32_16x16x32_bf16 v[44:47], v[220:223], v[228:231], v[44:47]
    v_perm_b32 v214, v102, v98, s57
    v_perm_b32 v215, v110, v106, s57
    v_mfma_f32_16x16x32_bf16 v[48:51], v[208:211], v[224:227], v[48:51]
    buffer_load_dwordx4 v[192:195], v4, s[36:39], s60 offen offset:0
    v_perm_b32 v216, v87, v83, s56
    v_perm_b32 v217, v95, v91, s56
    v_mfma_f32_16x16x32_bf16 v[52:55], v[208:211], v[228:231], v[52:55]
    v_perm_b32 v218, v103, v99, s56
    v_perm_b32 v219, v111, v107, s56
    v_mfma_f32_16x16x32_bf16 v[56:59], v[212:215], v[224:227], v[56:59]
    buffer_load_dwordx4 v[196:199], v4, s[36:39], s60 offen offset:1024
    v_perm_b32 v220, v87, v83, s57
    v_perm_b32 v221, v95, v91, s57
    v_mfma_f32_16x16x32_bf16 v[60:63], v[212:215], v[228:231], v[60:63]
    v_perm_b32 v222, v103, v99, s57
    v_perm_b32 v223, v111, v107, s57
    v_mfma_f32_16x16x32_bf16 v[64:67], v[216:219], v[224:227], v[64:67]
    buffer_load_dwordx4 v[200:203], v4, s[36:39], s60 offen offset:2048
    v_mfma_f32_16x16x32_bf16 v[68:71], v[216:219], v[228:231], v[68:71]
    v_mfma_f32_16x16x32_bf16 v[72:75], v[220:223], v[224:227], v[72:75]
    buffer_load_dwordx4 v[204:207], v4, s[36:39], s60 offen offset:3072
    v_mfma_f32_16x16x32_bf16 v[76:79], v[220:223], v[228:231], v[76:79]
    s_add_u32 s62, s58, s61
    s_and_b32 s69, s62, 6
    s_and_b32 s62, s62, 1
    s_lshl_b32 s69, s69, 1
    s_or_b32 s62, s62, s69
    s_and_b32 s69, s61, 8
    s_lshr_b32 s69, s69, 2
    s_or_b32 s62, s62, s69
    s_lshl_b32 s62, s62, 6
    s_add_u32 s61, s61, 1
    v_xor_b32 v10, s62, v9
    ds_read_b128 v[224:227], v10
    ds_read_b128 v[228:231], v10 offset:16384
    s_waitcnt vmcnt(16) lgkmcnt(2)
    v_perm_b32 v208, v116, v112, s56
    v_perm_b32 v209, v124, v120, s56
    v_perm_b32 v210, v132, v128, s56
    v_perm_b32 v211, v140, v136, s56
    v_perm_b32 v212, v116, v112, s57
    v_perm_b32 v213, v124, v120, s57
    v_perm_b32 v214, v132, v128, s57
    v_perm_b32 v215, v140, v136, s57
    v_mfma_f32_16x16x32_bf16 v[16:19], v[208:211], v[232:235], v[16:19]
    v_perm_b32 v216, v117, v113, s56
    v_perm_b32 v217, v125, v121, s56
    v_mfma_f32_16x16x32_bf16 v[20:23], v[208:211], v[236:239], v[20:23]
    v_perm_b32 v218, v133, v129, s56
    v_perm_b32 v219, v141, v137, s56
    v_mfma_f32_16x16x32_bf16 v[24:27], v[212:215], v[232:235], v[24:27]
    v_perm_b32 v220, v117, v113, s57
    v_perm_b32 v221, v125, v121, s57
    v_mfma_f32_16x16x32_bf16 v[28:31], v[212:215], v[236:239], v[28:31]
    v_perm_b32 v222, v133, v129, s57
    v_perm_b32 v223, v141, v137, s57
    v_mfma_f32_16x16x32_bf16 v[32:35], v[216:219], v[232:235], v[32:35]
    v_perm_b32 v208, v118, v114, s56
    v_perm_b32 v209, v126, v122, s56
    v_mfma_f32_16x16x32_bf16 v[36:39], v[216:219], v[236:239], v[36:39]
    v_perm_b32 v210, v134, v130, s56
    v_perm_b32 v211, v142, v138, s56
    v_mfma_f32_16x16x32_bf16 v[40:43], v[220:223], v[232:235], v[40:43]
    v_perm_b32 v212, v118, v114, s57
    v_perm_b32 v213, v126, v122, s57
    v_mfma_f32_16x16x32_bf16 v[44:47], v[220:223], v[236:239], v[44:47]
    v_perm_b32 v214, v134, v130, s57
    v_perm_b32 v215, v142, v138, s57
    v_mfma_f32_16x16x32_bf16 v[48:51], v[208:211], v[232:235], v[48:51]
    v_perm_b32 v216, v119, v115, s56
    v_perm_b32 v217, v127, v123, s56
    v_mfma_f32_16x16x32_bf16 v[52:55], v[208:211], v[236:239], v[52:55]
    v_perm_b32 v218, v135, v131, s56
    v_perm_b32 v219, v143, v139, s56
    v_mfma_f32_16x16x32_bf16 v[56:59], v[212:215], v[232:235], v[56:59]
    v_perm_b32 v220, v119, v115, s57
    v_perm_b32 v221, v127, v123, s57
    v_mfma_f32_16x16x32_bf16 v[60:63], v[212:215], v[236:239], v[60:63]
    v_perm_b32 v222, v135, v131, s57
    v_perm_b32 v223, v143, v139, s57
    v_mfma_f32_16x16x32_bf16 v[64:67], v[216:219], v[232:235], v[64:67]
    v_mfma_f32_16x16x32_bf16 v[68:71], v[216:219], v[236:239], v[68:71]
    v_mfma_f32_16x16x32_bf16 v[72:75], v[220:223], v[232:235], v[72:75]
    v_mfma_f32_16x16x32_bf16 v[76:79], v[220:223], v[236:239], v[76:79]
    s_add_u32 s62, s58, s61
    s_and_b32 s69, s62, 6
    s_and_b32 s62, s62, 1
    s_lshl_b32 s69, s69, 1
    s_or_b32 s62, s62, s69
    s_and_b32 s69, s61, 8
    s_lshr_b32 s69, s69, 2
    s_or_b32 s62, s62, s69
    s_lshl_b32 s62, s62, 6
    s_add_u32 s61, s61, 1
    v_xor_b32 v10, s62, v9
    ds_read_b128 v[232:235], v10
    ds_read_b128 v[236:239], v10 offset:16384
    s_waitcnt vmcnt(8) lgkmcnt(2)
    v_perm_b32 v208, v148, v144, s56
    v_perm_b32 v209, v156, v152, s56
    v_perm_b32 v210, v164, v160, s56
    v_perm_b32 v211, v172, v168, s56
    v_perm_b32 v212, v148, v144, s57
    v_perm_b32 v213, v156, v152, s57
    v_perm_b32 v214, v164, v160, s57
    v_perm_b32 v215, v172, v168, s57
    v_mfma_f32_16x16x32_bf16 v[16:19], v[208:211], v[224:227], v[16:19]
    v_perm_b32 v216, v149, v145, s56
    v_perm_b32 v217, v157, v153, s56
    v_mfma_f32_16x16x32_bf16 v[20:23], v[208:211], v[228:231], v[20:23]
    v_perm_b32 v218, v165, v161, s56
    v_perm_b32 v219, v173, v169, s56
    v_mfma_f32_16x16x32_bf16 v[24:27], v[212:215], v[224:227], v[24:27]
    v_perm_b32 v220, v149, v145, s57
    v_perm_b32 v221, v157, v153, s57
    v_mfma_f32_16x16x32_bf16 v[28:31], v[212:215], v[228:231], v[28:31]
    v_perm_b32 v222, v165, v161, s57
    v_perm_b32 v223, v173, v169, s57
    v_mfma_f32_16x16x32_bf16 v[32:35], v[216:219], v[224:227], v[32:35]
    v_perm_b32 v208, v150, v146, s56
    v_perm_b32 v209, v158, v154, s56
    v_mfma_f32_16x16x32_bf16 v[36:39], v[216:219], v[228:231], v[36:39]
    v_perm_b32 v210, v166, v162, s56
    v_perm_b32 v211, v174, v170, s56
    v_mfma_f32_16x16x32_bf16 v[40:43], v[220:223], v[224:227], v[40:43]
    v_perm_b32 v212, v150, v146, s57
    v_perm_b32 v213, v158, v154, s57
    v_mfma_f32_16x16x32_bf16 v[44:47], v[220:223], v[228:231], v[44:47]
    v_perm_b32 v214, v166, v162, s57
    v_perm_b32 v215, v174, v170, s57
    v_mfma_f32_16x16x32_bf16 v[48:51], v[208:211], v[224:227], v[48:51]
    v_perm_b32 v216, v151, v147, s56
    v_perm_b32 v217, v159, v155, s56
    v_mfma_f32_16x16x32_bf16 v[52:55], v[208:211], v[228:231], v[52:55]
    v_perm_b32 v218, v167, v163, s56
    v_perm_b32 v219, v175, v171, s56
    v_mfma_f32_16x16x32_bf16 v[56:59], v[212:215], v[224:227], v[56:59]
    v_perm_b32 v220, v151, v147, s57
    v_perm_b32 v221, v159, v155, s57
    v_mfma_f32_16x16x32_bf16 v[60:63], v[212:215], v[228:231], v[60:63]
    v_perm_b32 v222, v167, v163, s57
    v_perm_b32 v223, v175, v171, s57
    v_mfma_f32_16x16x32_bf16 v[64:67], v[216:219], v[224:227], v[64:67]
    v_mfma_f32_16x16x32_bf16 v[68:71], v[216:219], v[228:231], v[68:71]
    v_mfma_f32_16x16x32_bf16 v[72:75], v[220:223], v[224:227], v[72:75]
    v_mfma_f32_16x16x32_bf16 v[76:79], v[220:223], v[228:231], v[76:79]
    s_waitcnt vmcnt(0) lgkmcnt(0)
    v_perm_b32 v208, v180, v176, s56
    v_perm_b32 v209, v188, v184, s56
    v_perm_b32 v210, v196, v192, s56
    v_perm_b32 v211, v204, v200, s56
    v_perm_b32 v212, v180, v176, s57
    v_perm_b32 v213, v188, v184, s57
    v_perm_b32 v214, v196, v192, s57
    v_perm_b32 v215, v204, v200, s57
    v_mfma_f32_16x16x32_bf16 v[16:19], v[208:211], v[232:235], v[16:19]
    v_perm_b32 v216, v181, v177, s56
    v_perm_b32 v217, v189, v185, s56
    v_mfma_f32_16x16x32_bf16 v[20:23], v[208:211], v[236:239], v[20:23]
    v_perm_b32 v218, v197, v193, s56
    v_perm_b32 v219, v205, v201, s56
    v_mfma_f32_16x16x32_bf16 v[24:27], v[212:215], v[232:235], v[24:27]
    v_perm_b32 v220, v181, v177, s57
    v_perm_b32 v221, v189, v185, s57
    v_mfma_f32_16x16x32_bf16 v[28:31], v[212:215], v[236:239], v[28:31]
    v_perm_b32 v222, v197, v193, s57
    v_perm_b32 v223, v205, v201, s57
    v_mfma_f32_16x16x32_bf16 v[32:35], v[216:219], v[232:235], v[32:35]
    v_perm_b32 v208, v182, v178, s56
    v_perm_b32 v209, v190, v186, s56
    v_mfma_f32_16x16x32_bf16 v[36:39], v[216:219], v[236:239], v[36:39]
    v_perm_b32 v210, v198, v194, s56
    v_perm_b32 v211, v206, v202, s56
    v_mfma_f32_16x16x32_bf16 v[40:43], v[220:223], v[232:235], v[40:43]
    v_perm_b32 v212, v182, v178, s57
    v_perm_b32 v213, v190, v186, s57
    v_mfma_f32_16x16x32_bf16 v[44:47], v[220:223], v[236:239], v[44:47]
    v_perm_b32 v214, v198, v194, s57
    v_perm_b32 v215, v206, v202, s57
    v_mfma_f32_16x16x32_bf16 v[48:51], v[208:211], v[232:235], v[48:51]
    v_perm_b32 v216, v183, v179, s56
    v_perm_b32 v217, v191, v187, s56
    v_mfma_f32_16x16x32_bf16 v[52:55], v[208:211], v[236:239], v[52:55]
    v_perm_b32 v218, v199, v195, s56
    v_perm_b32 v219, v207, v203, s56
    v_mfma_f32_16x16x32_bf16 v[56:59], v[212:215], v[232:235], v[56:59]
    v_perm_b32 v220, v183, v179, s57
    v_perm_b32 v221, v191, v187, s57
    v_mfma_f32_16x16x32_bf16 v[60:63], v[212:215], v[236:239], v[60:63]
    v_perm_b32 v222, v199, v195, s57
    v_perm_b32 v223, v207, v203, s57
    v_mfma_f32_16x16x32_bf16 v[64:67], v[216:219], v[232:235], v[64:67]
    v_mfma_f32_16x16x32_bf16 v[68:71], v[216:219], v[236:239], v[68:71]
    v_mfma_f32_16x16x32_bf16 v[72:75], v[220:223], v[232:235], v[72:75]
    v_mfma_f32_16x16x32_bf16 v[76:79], v[220:223], v[236:239], v[76:79]
    s_nop 7
    v_lshlrev_b32 v1, 4, v0
    s_lshl_b32 s70, s23, 13
    v_cvt_pk_bf16_f32 v80, v16, v24
    v_cvt_pk_bf16_f32 v81, v32, v40
    v_cvt_pk_bf16_f32 v82, v48, v56
    v_cvt_pk_bf16_f32 v83, v64, v72
    buffer_store_dwordx4 v[80:83], v1, s[40:43], s70 offen offset:0 sc1
    v_cvt_pk_bf16_f32 v84, v17, v25
    v_cvt_pk_bf16_f32 v85, v33, v41
    v_cvt_pk_bf16_f32 v86, v49, v57
    v_cvt_pk_bf16_f32 v87, v65, v73
    buffer_store_dwordx4 v[84:87], v1, s[40:43], s70 offen offset:1024 sc1
    v_cvt_pk_bf16_f32 v88, v18, v26
    v_cvt_pk_bf16_f32 v89, v34, v42
    v_cvt_pk_bf16_f32 v90, v50, v58
    v_cvt_pk_bf16_f32 v91, v66, v74
    buffer_store_dwordx4 v[88:91], v1, s[40:43], s70 offen offset:2048 sc1
    v_cvt_pk_bf16_f32 v92, v19, v27
    v_cvt_pk_bf16_f32 v93, v35, v43
    v_cvt_pk_bf16_f32 v94, v51, v59
    v_cvt_pk_bf16_f32 v95, v67, v75
    buffer_store_dwordx4 v[92:95], v1, s[40:43], s70 offen offset:3072 sc1
    s_add_u32 s70, s70, 4096
    v_cvt_pk_bf16_f32 v96, v20, v28
    v_cvt_pk_bf16_f32 v97, v36, v44
    v_cvt_pk_bf16_f32 v98, v52, v60
    v_cvt_pk_bf16_f32 v99, v68, v76
    buffer_store_dwordx4 v[96:99], v1, s[40:43], s70 offen offset:0 sc1
    v_cvt_pk_bf16_f32 v100, v21, v29
    v_cvt_pk_bf16_f32 v101, v37, v45
    v_cvt_pk_bf16_f32 v102, v53, v61
    v_cvt_pk_bf16_f32 v103, v69, v77
    buffer_store_dwordx4 v[100:103], v1, s[40:43], s70 offen offset:1024 sc1
    v_cvt_pk_bf16_f32 v104, v22, v30
    v_cvt_pk_bf16_f32 v105, v38, v46
    v_cvt_pk_bf16_f32 v106, v54, v62
    v_cvt_pk_bf16_f32 v107, v70, v78
    buffer_store_dwordx4 v[104:107], v1, s[40:43], s70 offen offset:2048 sc1
    v_cvt_pk_bf16_f32 v108, v23, v31
    v_cvt_pk_bf16_f32 v109, v39, v47
    v_cvt_pk_bf16_f32 v110, v55, v63
    v_cvt_pk_bf16_f32 v111, v71, v79
    buffer_store_dwordx4 v[108:111], v1, s[40:43], s70 offen offset:3072 sc1
    s_lshl_b32 s70, s22, 9
    s_lshl_b32 s71, s23, 7
    s_add_u32 s70, s70, s71
    s_lshl_b32 s71, s21, 2
    s_add_u32 s70, s70, s71
    v_mov_b32 v2, 0
    v_mov_b32 v3, 1
    s_lshr_b32 s71, s21, 1
    s_lshl_b32 s71, s71, 7
    s_lshl_b32 s72, s22, 9
    s_add_u32 s71, s71, s72
    v_and_b32 v4, 7, v0
    v_lshlrev_b32 v4, 2, v4
    global_load_dword v240, v241, s[16:17] sc1
    s_mov_b32 s74, 0x40000
L_chk:
    s_waitcnt vmcnt(0)
    v_readfirstlane_b32 s75, v240
    s_sub_u32 s74, s74, 1
    s_cmp_ge_u32 s75, 8
    s_cbranch_scc1 L_nochk
    s_cmp_eq_u32 s74, 0
    s_cbranch_scc1 L_nochk
    global_load_dword v240, v241, s[16:17] sc1
    s_branch L_chk
L_nochk:
    v_cmp_eq_u32 vcc, 0, v0
    s_and_saveexec_b64 s[72:73], vcc
    buffer_store_dword v3, v2, s[48:51], s70 offen sc1
    s_mov_b64 exec, s[72:73]
    s_lshl_b32 s72, s22, 18
    s_add_u32 s40, s18, s72
    s_addc_u32 s41, s19, 0
    s_mov_b32 s42, 262144
    s_mov_b32 s43, 0x20000
    s_lshl_b32 s72, s21, 12
    s_add_u32 s72, s72, s66
    v_add_u32 v1, s72, v1
    s_mov_b32 s73, 0x40000
L_poll:
    buffer_load_dword v5, v4, s[48:51], s71 offen sc1
    s_sub_u32 s73, s73, 1
    s_waitcnt vmcnt(0)
    v_cmp_ne_u32 vcc, 1, v5
    s_cmp_eq_u32 s73, 0
    s_cbranch_scc1 L_polled
    s_cbranch_vccnz L_poll
L_polled:
    s_mov_b32 s70, 0
    buffer_load_dwordx4 v[16:19], v1, s[40:43], s70 offen sc1
    s_mov_b32 s70, 32768
    buffer_load_dwordx4 v[20:23], v1, s[40:43], s70 offen sc1
    s_mov_b32 s70, 65536
    buffer_load_dwordx4 v[24:27], v1, s[40:43], s70 offen sc1
    s_mov_b32 s70, 98304
    buffer_load_dwordx4 v[28:31], v1, s[40:43], s70 offen sc1
    s_mov_b32 s70, 131072
    buffer_load_dwordx4 v[32:35], v1, s[40:43], s70 offen sc1
    s_mov_b32 s70, 163840
    buffer_load_dwordx4 v[36:39], v1, s[40:43], s70 offen sc1
    s_mov_b32 s70, 196608
    buffer_load_dwordx4 v[40:43], v1, s[40:43], s70 offen sc1
    s_mov_b32 s70, 229376
    buffer_load_dwordx4 v[44:47], v1, s[40:43], s70 offen sc1
    v_and_b32 v3, 15, v0
    v_lshrrev_b32 v4, 4, v0
    s_and_b32 s70, s21, 1
    s_lshl_b32 s70, s70, 4
    s_lshl_b32 s71, s22, 5
    s_add_u32 s70, s70, s71
    s_lshl_b32 s70, s70, 10
    s_lshr_b32 s71, s21, 1
    s_lshl_b32 s71, s71, 8
    s_add_u32 s70, s70, s71
    s_lshl_b32 s71, s23, 4
    s_add_u32 s70, s70, s71
    v_lshlrev_b32 v3, 10, v3
    v_lshl_add_u32 v3, v4, 6, v3
    v_add_u32 v3, s70, v3
    s_waitcnt vmcnt(7)
    v_lshlrev_b32 v48, 16, v16
    v_and_b32 v49, 0xffff0000, v16
    v_lshlrev_b32 v50, 16, v17
    v_and_b32 v51, 0xffff0000, v17
    v_lshlrev_b32 v52, 16, v18
    v_and_b32 v53, 0xffff0000, v18
    v_lshlrev_b32 v54, 16, v19
    v_and_b32 v55, 0xffff0000, v19
    s_waitcnt vmcnt(6)
    v_lshlrev_b32 v5, 16, v20
    v_and_b32 v6, 0xffff0000, v20
    v_add_f32 v48, v48, v5
    v_add_f32 v49, v49, v6
    v_lshlrev_b32 v5, 16, v21
    v_and_b32 v6, 0xffff0000, v21
    v_add_f32 v50, v50, v5
    v_add_f32 v51, v51, v6
    v_lshlrev_b32 v5, 16, v22
    v_and_b32 v6, 0xffff0000, v22
    v_add_f32 v52, v52, v5
    v_add_f32 v53, v53, v6
    v_lshlrev_b32 v5, 16, v23
    v_and_b32 v6, 0xffff0000, v23
    v_add_f32 v54, v54, v5
    v_add_f32 v55, v55, v6
    s_waitcnt vmcnt(5)
    v_lshlrev_b32 v5, 16, v24
    v_and_b32 v6, 0xffff0000, v24
    v_add_f32 v48, v48, v5
    v_add_f32 v49, v49, v6
    v_lshlrev_b32 v5, 16, v25
    v_and_b32 v6, 0xffff0000, v25
    v_add_f32 v50, v50, v5
    v_add_f32 v51, v51, v6
    v_lshlrev_b32 v5, 16, v26
    v_and_b32 v6, 0xffff0000, v26
    v_add_f32 v52, v52, v5
    v_add_f32 v53, v53, v6
    v_lshlrev_b32 v5, 16, v27
    v_and_b32 v6, 0xffff0000, v27
    v_add_f32 v54, v54, v5
    v_add_f32 v55, v55, v6
    s_waitcnt vmcnt(4)
    v_lshlrev_b32 v5, 16, v28
    v_and_b32 v6, 0xffff0000, v28
    v_add_f32 v48, v48, v5
    v_add_f32 v49, v49, v6
    v_lshlrev_b32 v5, 16, v29
    v_and_b32 v6, 0xffff0000, v29
    v_add_f32 v50, v50, v5
    v_add_f32 v51, v51, v6
    v_lshlrev_b32 v5, 16, v30
    v_and_b32 v6, 0xffff0000, v30
    v_add_f32 v52, v52, v5
    v_add_f32 v53, v53, v6
    v_lshlrev_b32 v5, 16, v31
    v_and_b32 v6, 0xffff0000, v31
    v_add_f32 v54, v54, v5
    v_add_f32 v55, v55, v6
    s_waitcnt vmcnt(3)
    v_lshlrev_b32 v5, 16, v32
    v_and_b32 v6, 0xffff0000, v32
    v_add_f32 v48, v48, v5
    v_add_f32 v49, v49, v6
    v_lshlrev_b32 v5, 16, v33
    v_and_b32 v6, 0xffff0000, v33
    v_add_f32 v50, v50, v5
    v_add_f32 v51, v51, v6
    v_lshlrev_b32 v5, 16, v34
    v_and_b32 v6, 0xffff0000, v34
    v_add_f32 v52, v52, v5
    v_add_f32 v53, v53, v6
    v_lshlrev_b32 v5, 16, v35
    v_and_b32 v6, 0xffff0000, v35
    v_add_f32 v54, v54, v5
    v_add_f32 v55, v55, v6
    s_waitcnt vmcnt(2)
    v_lshlrev_b32 v5, 16, v36
    v_and_b32 v6, 0xffff0000, v36
    v_add_f32 v48, v48, v5
    v_add_f32 v49, v49, v6
    v_lshlrev_b32 v5, 16, v37
    v_and_b32 v6, 0xffff0000, v37
    v_add_f32 v50, v50, v5
    v_add_f32 v51, v51, v6
    v_lshlrev_b32 v5, 16, v38
    v_and_b32 v6, 0xffff0000, v38
    v_add_f32 v52, v52, v5
    v_add_f32 v53, v53, v6
    v_lshlrev_b32 v5, 16, v39
    v_and_b32 v6, 0xffff0000, v39
    v_add_f32 v54, v54, v5
    v_add_f32 v55, v55, v6
    s_waitcnt vmcnt(1)
    v_lshlrev_b32 v5, 16, v40
    v_and_b32 v6, 0xffff0000, v40
    v_add_f32 v48, v48, v5
    v_add_f32 v49, v49, v6
    v_lshlrev_b32 v5, 16, v41
    v_and_b32 v6, 0xffff0000, v41
    v_add_f32 v50, v50, v5
    v_add_f32 v51, v51, v6
    v_lshlrev_b32 v5, 16, v42
    v_and_b32 v6, 0xffff0000, v42
    v_add_f32 v52, v52, v5
    v_add_f32 v53, v53, v6
    v_lshlrev_b32 v5, 16, v43
    v_and_b32 v6, 0xffff0000, v43
    v_add_f32 v54, v54, v5
    v_add_f32 v55, v55, v6
    s_waitcnt vmcnt(0)
    v_lshlrev_b32 v5, 16, v44
    v_and_b32 v6, 0xffff0000, v44
    v_add_f32 v48, v48, v5
    v_add_f32 v49, v49, v6
    v_lshlrev_b32 v5, 16, v45
    v_and_b32 v6, 0xffff0000, v45
    v_add_f32 v50, v50, v5
    v_add_f32 v51, v51, v6
    v_lshlrev_b32 v5, 16, v46
    v_and_b32 v6, 0xffff0000, v46
    v_add_f32 v52, v52, v5
    v_add_f32 v53, v53, v6
    v_lshlrev_b32 v5, 16, v47
    v_and_b32 v6, 0xffff0000, v47
    v_add_f32 v54, v54, v5
    v_add_f32 v55, v55, v6
    v_cvt_pk_bf16_f32 v56, v48, v49
    v_cvt_pk_bf16_f32 v57, v50, v51
    v_cvt_pk_bf16_f32 v58, v52, v53
    v_cvt_pk_bf16_f32 v59, v54, v55
    buffer_store_dwordx4 v[56:59], v3, s[52:55], 0 offen
L_end:
    s_endpgm
L_code_end:

.section .rodata,"a"
.p2align 6
.amdhsa_kernel standalone__sliding_block_cached__sampling_kernel
  .amdhsa_next_free_vgpr 256
  .amdhsa_next_free_sgpr 102
  .amdhsa_accum_offset 256
  .amdhsa_group_segment_fixed_size 0
  .amdhsa_kernarg_size 64
  .amdhsa_user_sgpr_count 2
  .amdhsa_user_sgpr_kernarg_segment_ptr 1
  .amdhsa_system_sgpr_workgroup_id_x 1
.end_amdhsa_kernel
```
